```python
import torch

def _softmax(x, axis=-1):
    return torch.softmax(x, dim=axis)
def _gelu(x):
    return torch.nn.functional.gelu(x, approximate="tanh")
def _silu(x):
    return torch.nn.functional.silu(x)
def _sigmoid(x):
    return torch.sigmoid(x)
def _layernorm(x, axis=-1, eps=1e-5):
    m = x.mean(dim=axis, keepdim=True)
    v = x.var(dim=axis, keepdim=True, unbiased=False)
    return (x - m) / torch.sqrt(v + eps)
def _scatter_add(tgt, idx, src, axis=0):
    return tgt.clone().index_add_(axis, idx, src)
def _segment_sum(src, seg, n):
    out = torch.zeros((n,) + src.shape[1:], dtype=src.dtype)
    return out.index_add_(0, seg, src)
def _pad(x, pw):
    flat = tuple(v for pair in reversed(pw) for v in pair)
    return torch.nn.functional.pad(x, flat)

kernel_name = 'recurrent_scan__sliding_block_cached__swiglu_ffn__decode'

def setup_inputs():

    _w = (lambda a: (lambda t: t.to(torch.bfloat16) if t.is_floating_point() else t)(torch.as_tensor(a)))
    def _A_setup():
        B, Sq, D = 4, 1, 512
        Hq, Hkv, Sk, Dh = 32, 8, 16384, 128
        assert Hq % Hkv == 0, (Hq, Hkv)
        return {
            "x": _w((lambda *s: torch.randn(*s, dtype=torch.bfloat16) * 0.05)(B, Sq, D)),
            "k_cache": _w((lambda *s: torch.randn(*s, dtype=torch.bfloat16) * 1.6)(B, Hkv, Sk, Dh)),
            "v_cache": _w((lambda *s: torch.randn(*s, dtype=torch.bfloat16) * 0.2)(B, Hkv, Sk, Dh)),
            "wq": _w((lambda *s: torch.randn(*s, dtype=torch.bfloat16) * 1.6)(D, Hq * Dh) * (D ** -0.5)),
            "wo": _w((lambda *s: torch.randn(*s, dtype=torch.bfloat16) * 0.2)(Hq * Dh, D) * ((Hq * Dh) ** -0.5)),
        }
    _A_in = _A_setup()

    def _B_setup():
        B, S, D, F = 4, 1, 512, 1792
        return {
            "x": _w((lambda *s: torch.randn(*s, dtype=torch.bfloat16) * 0.05)(B, S, D)),
            "w_gate": _w((lambda *s: torch.randn(*s, dtype=torch.bfloat16) * 0.1)(D, F)),
            "w_up": _w((lambda *s: torch.randn(*s, dtype=torch.bfloat16) * 0.1)(D, F)),
            "w_down": _w((lambda *s: torch.randn(*s, dtype=torch.bfloat16) * 0.1)(F, D)),
        }
    _B_in = _B_setup()

    return {
        "A_x": _A_in["x"],
        "A_k_cache": _A_in["k_cache"],
        "A_v_cache": _A_in["v_cache"],
        "A_wq": _A_in["wq"],
        "A_wo": _A_in["wo"],
        "B_x": _B_in["x"],
        "B_w_gate": _B_in["w_gate"],
        "B_w_up": _B_in["w_up"],
        "B_w_down": _B_in["w_down"],
    }

def reference(A_x, A_k_cache, A_v_cache, A_wq, A_wo, B_x, B_w_gate, B_w_up, B_w_down):
    def _A_ref(x, k_cache, v_cache, wq, wo):
        B, Sq, D = x.shape
        Hq, Dh = 32, 128
        Hkv, Sk = k_cache.shape[1], k_cache.shape[2]
        W = min(4096, max(256, Sk // 4))
        rep = Hq // Hkv
        q = (lambda x, *d: x.permute(*d))((x @ wq).reshape(B, Sq, Hq, Dh), 0, 2, 1, 3)
        k = (lambda x, n, axis: torch.repeat_interleave(x, n, dim=axis))(k_cache[:, :, Sk - W:, :], rep, axis=1)
        v = (lambda x, n, axis: torch.repeat_interleave(x, n, dim=axis))(v_cache[:, :, Sk - W:, :], rep, axis=1)
        scores = torch.einsum("bhqd,bhkd->bhqk", q, k) * (Dh ** -0.5)
        p = _softmax(scores, axis=-1)
        o = torch.einsum("bhqk,bhkd->bhqd", p, v)
        return (lambda x, *d: x.permute(*d))(o, 0, 2, 1, 3).reshape(B, Sq, Hq * Dh) @ wo

    def _B_ref(x, w_gate, w_up, w_down):
        g = _silu(x @ w_gate)
        u = x @ w_up
        return (g * u) @ w_down

    x = A_x
    xn = _layernorm(x, axis=-1)
    s = _A_ref(xn, A_k_cache, A_v_cache, A_wq, A_wo)
    g = _silu(_B_ref(xn, B_w_gate, B_w_up, B_w_down))
    return x + s * g
```

```asm
; @launch grid=(256,1,1) block=(768,1,1) lds=82944
.amdgcn_target "amdgcn-amd-amdhsa--gfx950"
.text
.globl recurrent_scan__sliding_block_cached__swiglu_ffn__decode_kernel
.p2align 12
.fill 832, 4, 0xbf800000
.p2align 8
.type recurrent_scan__sliding_block_cached__swiglu_ffn__decode_kernel,@function
recurrent_scan__sliding_block_cached__swiglu_ffn__decode_kernel:
    s_load_dwordx16 s[4:19], s[0:1], 0
    s_load_dwordx8 s[20:27], s[0:1], 64
    v_lshrrev_b32 v1, 6, v0
    s_cmp_ge_u32 s2, 256
    s_cbranch_scc1 L_end
    v_readfirstlane_b32 s3, v1
    v_and_b32 v0, 63, v0
    s_and_b32 s28, s2, 7
    s_lshr_b32 s29, s2, 3
    s_lshr_b32 s30, s2, 6
    s_and_b32 s31, s29, 7
    s_lshr_b32 s76, s29, 2
    s_and_b32 s75, s2, 31
    v_lshrrev_b32 v9, 3, v0
    v_and_b32 v8, 7, v0
    v_lshlrev_b32 v8, 4, v8
    s_sub_u32 s54, s3, 4
    s_cbranch_scc1 L_help
    v_lshl_add_u32 v6, v9, 13, v8
    s_lshl_b32 s56, s30, 4
    s_add_u32 s56, s56, s54
    s_lshl_b32 s56, s56, 6
    s_add_u32 s56, s56, s28
    s_lshl_b32 s56, s56, 3
    s_add_u32 s56, s56, s31
    s_lshl_b32 s56, s56, 7
    s_lshl_b32 s73, s54, 10
    s_mov_b32 s46, 0x400000
    s_mov_b32 s47, 0x20000
    s_add_u32 m0, s73, 8192
    s_add_u32 s57, s56, 0x80000
    v_mul_u32_u24 v7, 3584, v9
    v_add_u32 v7, v7, v8
    s_lshl_b32 s72, s76, 3
    s_add_u32 s72, s72, s54
    s_mul_i32 s58, s72, 28672
    s_lshl_b32 s72, s75, 7
    s_add_u32 s58, s58, s72
    s_cmp_lt_u32 s75, 28
    s_cselect_b32 s42, 0x1c0000, 0
    s_mov_b32 s43, s47
    s_waitcnt lgkmcnt(0)
    s_mov_b64 s[44:45], s[10:11]
    buffer_load_dwordx4 v6, s[44:47], s56 offen nt lds
    s_mov_b64 s[40:41], s[16:17]
    s_add_u32 m0, s73, 16384
    s_nop 0
    buffer_load_dwordx4 v6, s[44:47], s57 offen nt lds
    s_add_u32 m0, s73, 24576
    s_nop 0
    buffer_load_dwordx4 v7, s[40:43], s58 offen nt lds
    s_mov_b64 s[36:37], s[18:19]
    s_mov_b32 s38, s42
    s_mov_b32 s39, 0x20000
    s_load_dword s52, s[26:27], 0
    s_lshl_b32 s77, s28, 2
    s_add_u32 s77, s77, s30
    s_mov_b32 s53, 0
    v_mov_b32 v1, 2560
    v_mov_b32 v2, 0xffffff00
    v_lshrrev_b32 v3, 4, v0
    v_and_b32 v11, 3, v0
    v_bfe_u32 v10, v0, 2, 2
    v_lshlrev_b32 v4, 4, v11
    v_lshl_add_u32 v4, v10, 8, v4
    v_lshl_add_u32 v4, v3, 6, v4
    v_lshlrev_b32 v5, 4, v0
    s_lshl_b32 s55, s30, 3
    s_add_u32 s55, s55, s28
    s_lshl_b32 s55, s55, 22
    s_lshl_b32 s72, s31, 17
    s_add_u32 s55, s55, s72
    s_add_u32 s55, s55, 0x300000
    s_add_u32 s72, s31, s28
    s_lshl_b32 s72, s72, 12
    s_add_u32 s74, s73, s72
    s_lshl_b32 s72, s30, 15
    s_add_u32 s74, s74, s72
    s_add_u32 s32, s6, s55
    s_addc_u32 s33, s7, 0
    s_mov_b32 s34, 0x20000
    s_mov_b32 s35, 0x20000
    s_mov_b32 s75, 0x1ffff
    s_barrier
    s_and_b32 s72, s54, 1
    s_lshl_b32 s72, s72, 6
    v_and_b32 v6, 1, v3
    v_lshlrev_b32 v6, 5, v6
    v_or_b32 v6, s72, v6
    v_xor_b32 v6, v6, v8
    v_lshl_add_u32 v6, v9, 10, v6
    s_waitcnt vmcnt(2)
    s_add_u32 m0, s73, 32768
    s_nop 0
    buffer_load_dwordx4 v7, s[36:39], s58 offen nt lds
    s_add_u32 s36, s8, s55
    s_addc_u32 s37, s9, 0
    s_mov_b32 s38, 0x20000
    s_cmp_lt_u32 s29, 28
    s_cselect_b32 s46, 0x1c0000, 0
    s_mov_b64 s[44:45], s[20:21]
    s_mov_b64 s[40:41], s[12:13]
    s_mov_b32 s42, 0x400000
    v_lshl_add_u32 v12, v9, 10, v8
    s_lshl_b32 s78, s29, 3
    s_add_u32 s78, s78, s54
    s_lshl_b32 s78, s78, 6
    s_add_u32 s78, s78, s28
    s_lshl_b32 s78, s78, 7
    v_and_b32 v7, 1, v0
    v_lshlrev_b32 v7, 4, v7
    v_mov_b32 v8, 0xffff
    v_lshlrev_b32 v7, v7, v8
    v_cmp_gt_u32 vcc, 2, v11
    s_nop 1
    v_cndmask_b32 v8, 0, v7, vcc
    v_cndmask_b32 v9, v7, 0, vcc
    s_mov_b32 s79, 0x3fb8aa3b
    s_mov_b32 s76, 0
    s_and_b32 s56, s74, s75
    s_waitcnt vmcnt(2)
    buffer_load_dwordx4 v[32:35], v4, s[32:35], s56 offen nt
    v_mov_b32 v7, 1
    s_mov_b64 exec, 1
    ds_add_u32 v1, v7 offset:32
    s_mov_b64 exec, -1
    s_add_u32 s57, s56, 0x2000
    s_and_b32 s57, s57, s75
    s_waitcnt vmcnt(2)
    buffer_load_dwordx4 v[36:39], v4, s[32:35], s57 offen nt
    s_add_u32 s58, s57, 0x2000
    s_and_b32 s58, s58, s75
    s_waitcnt vmcnt(2)
    buffer_load_dwordx4 v[40:43], v4, s[32:35], s58 offen nt
    v_mov_b32 v7, 1
    s_mov_b64 exec, 1
    ds_add_u32 v1, v7 offset:36
    s_mov_b64 exec, -1
    s_add_u32 s59, s58, 0x2000
    s_and_b32 s59, s59, s75
    s_waitcnt vmcnt(2)
    buffer_load_dwordx4 v[44:47], v4, s[32:35], s59 offen nt
    s_add_u32 s60, s59, 0x2000
    s_and_b32 s60, s60, s75
    s_waitcnt vmcnt(2)
    buffer_load_dwordx4 v[48:51], v4, s[32:35], s60 offen nt
    s_add_u32 s61, s60, 0x2000
    s_and_b32 s61, s61, s75
    s_waitcnt vmcnt(2)
    buffer_load_dwordx4 v[52:55], v4, s[32:35], s61 offen nt
    s_add_u32 s62, s61, 0x2000
    s_and_b32 s62, s62, s75
    s_waitcnt vmcnt(2)
    buffer_load_dwordx4 v[56:59], v4, s[32:35], s62 offen nt
    s_add_u32 s63, s62, 0x2000
    s_and_b32 s63, s63, s75
    s_waitcnt vmcnt(2)
    buffer_load_dwordx4 v[60:63], v4, s[32:35], s63 offen nt
    s_add_u32 s64, s63, 0x2000
    s_and_b32 s64, s64, s75
    s_waitcnt vmcnt(2)
    buffer_load_dwordx4 v[64:67], v4, s[32:35], s64 offen nt
    s_waitcnt vmcnt(2)
    s_add_u32 m0, s73, 40960
    s_nop 0
    buffer_load_dwordx4 v12, s[44:47], s78 offen nt lds
    s_add_u32 s65, s64, 0x2000
    s_and_b32 s65, s65, s75
    s_waitcnt vmcnt(2)
    buffer_load_dwordx4 v[68:71], v4, s[32:35], s65 offen nt
    s_add_u32 s66, s65, 0x2000
    s_and_b32 s66, s66, s75
    s_waitcnt vmcnt(2)
    buffer_load_dwordx4 v[72:75], v4, s[32:35], s66 offen nt
    s_add_u32 s67, s66, 0x2000
    s_and_b32 s67, s67, s75
    s_waitcnt vmcnt(2)
    buffer_load_dwordx4 v[76:79], v4, s[32:35], s67 offen nt
    v_mov_b32 v7, 1
    s_mov_b64 exec, 1
    ds_add_u32 v1, v7 offset:48
    s_mov_b64 exec, -1
    s_add_u32 s68, s67, 0x2000
    s_and_b32 s68, s68, s75
    s_waitcnt vmcnt(2)
    buffer_load_dwordx4 v[80:83], v4, s[32:35], s68 offen nt
    s_add_u32 s69, s68, 0x2000
    s_and_b32 s69, s69, s75
    s_waitcnt vmcnt(2)
    buffer_load_dwordx4 v[84:87], v4, s[32:35], s69 offen nt
    s_add_u32 s70, s69, 0x2000
    s_and_b32 s70, s70, s75
    s_waitcnt vmcnt(2)
    buffer_load_dwordx4 v[88:91], v4, s[32:35], s70 offen nt
    v_mov_b32 v7, 1
    s_mov_b64 exec, 1
    ds_add_u32 v1, v7 offset:56
    s_mov_b64 exec, -1
    s_add_u32 s71, s70, 0x2000
    s_and_b32 s71, s71, s75
    s_waitcnt vmcnt(2)
    buffer_load_dwordx4 v[92:95], v4, s[32:35], s71 offen nt
    s_waitcnt lgkmcnt(0)
    s_add_u32 s52, s52, 2
    s_and_b32 s48, s52, 0xff
    s_xor_b32 s49, s48, 0x55
    s_xor_b32 s50, s48, 0xaa
    s_xor_b32 s51, s48, 0xff
    s_branch L_lw1
L_lwr1:
    s_sleep 1
L_lw1:
    ds_read_b32 v7, v1 offset:0
    s_add_u32 s53, s53, 1
    s_cmp_gt_u32 s53, 4194304
    s_cbranch_scc1 L_end
    s_waitcnt lgkmcnt(0)
    v_cmp_eq_u32 vcc, 0, v7
    s_cbranch_vccnz L_lwr1
    v_readfirstlane_b32 s78, v7
    ds_read_b128 v[12:15], v5 offset:3328
    s_waitcnt lgkmcnt(0)
    v_mfma_f32_16x16x32_bf16 v[16:19], v[32:35], v[12:15], 0
    v_mfma_f32_16x16x32_bf16 v[20:23], v[36:39], v[12:15], 0
    v_mfma_f32_16x16x32_bf16 v[24:27], v[40:43], v[12:15], 0
    v_mfma_f32_16x16x32_bf16 v[28:31], v[44:47], v[12:15], 0
    s_nop 4
    v_mov_b32_dpp v32, v16 quad_perm:[0,0,0,0] row_mask:0xf bank_mask:0xf
    v_mov_b32_dpp v36, v20 quad_perm:[0,0,0,0] row_mask:0xf bank_mask:0xf
    v_mov_b32_dpp v40, v24 quad_perm:[0,0,0,0] row_mask:0xf bank_mask:0xf
    v_mov_b32_dpp v44, v28 quad_perm:[0,0,0,0] row_mask:0xf bank_mask:0xf
    v_add_f32_dpp v32, v17, v32 quad_perm:[1,1,1,1] row_mask:0xf bank_mask:0xf
    v_add_f32_dpp v36, v21, v36 quad_perm:[1,1,1,1] row_mask:0xf bank_mask:0xf
    v_add_f32_dpp v40, v25, v40 quad_perm:[1,1,1,1] row_mask:0xf bank_mask:0xf
    v_add_f32_dpp v44, v29, v44 quad_perm:[1,1,1,1] row_mask:0xf bank_mask:0xf
    v_add_f32_dpp v32, v18, v32 quad_perm:[2,2,2,2] row_mask:0xf bank_mask:0xf
    v_add_f32_dpp v36, v22, v36 quad_perm:[2,2,2,2] row_mask:0xf bank_mask:0xf
    v_add_f32_dpp v40, v26, v40 quad_perm:[2,2,2,2] row_mask:0xf bank_mask:0xf
    v_add_f32_dpp v44, v30, v44 quad_perm:[2,2,2,2] row_mask:0xf bank_mask:0xf
    v_add_f32_dpp v32, v19, v32 quad_perm:[3,3,3,3] row_mask:0xf bank_mask:0xf
    v_add_f32_dpp v36, v23, v36 quad_perm:[3,3,3,3] row_mask:0xf bank_mask:0xf
    v_add_f32_dpp v40, v27, v40 quad_perm:[3,3,3,3] row_mask:0xf bank_mask:0xf
    v_add_f32_dpp v44, v31, v44 quad_perm:[3,3,3,3] row_mask:0xf bank_mask:0xf
    v_cvt_pk_bf16_f32 v32, 0, v32
    v_cvt_pk_bf16_f32 v36, 0, v36
    v_cvt_pk_bf16_f32 v40, 0, v40
    v_cvt_pk_bf16_f32 v44, 0, v44
    v_mul_f32 v32, 0x3db504f3, v32
    v_mul_f32 v36, 0x3db504f3, v36
    v_mul_f32 v40, 0x3db504f3, v40
    v_mul_f32 v44, 0x3db504f3, v44
    v_cvt_pk_bf16_f32 v32, 0, v32
    v_cvt_pk_bf16_f32 v36, 0, v36
    v_cvt_pk_bf16_f32 v40, 0, v40
    v_cvt_pk_bf16_f32 v44, 0, v44
    s_waitcnt vmcnt(2)
    buffer_load_dwordx4 v[96:99], v5, s[36:39], s56 offen nt
    v_mfma_f32_16x16x32_bf16 v[16:19], v[48:51], v[12:15], 0
    v_mfma_f32_16x16x32_bf16 v[20:23], v[52:55], v[12:15], 0
    v_mfma_f32_16x16x32_bf16 v[24:27], v[56:59], v[12:15], 0
    v_mfma_f32_16x16x32_bf16 v[28:31], v[60:63], v[12:15], 0
    s_nop 4
    v_mov_b32_dpp v48, v16 quad_perm:[0,0,0,0] row_mask:0xf bank_mask:0xf
    v_mov_b32_dpp v52, v20 quad_perm:[0,0,0,0] row_mask:0xf bank_mask:0xf
    v_mov_b32_dpp v56, v24 quad_perm:[0,0,0,0] row_mask:0xf bank_mask:0xf
    v_mov_b32_dpp v60, v28 quad_perm:[0,0,0,0] row_mask:0xf bank_mask:0xf
    v_add_f32_dpp v48, v17, v48 quad_perm:[1,1,1,1] row_mask:0xf bank_mask:0xf
    v_add_f32_dpp v52, v21, v52 quad_perm:[1,1,1,1] row_mask:0xf bank_mask:0xf
    v_add_f32_dpp v56, v25, v56 quad_perm:[1,1,1,1] row_mask:0xf bank_mask:0xf
    v_add_f32_dpp v60, v29, v60 quad_perm:[1,1,1,1] row_mask:0xf bank_mask:0xf
    v_add_f32_dpp v48, v18, v48 quad_perm:[2,2,2,2] row_mask:0xf bank_mask:0xf
    v_add_f32_dpp v52, v22, v52 quad_perm:[2,2,2,2] row_mask:0xf bank_mask:0xf
    v_add_f32_dpp v56, v26, v56 quad_perm:[2,2,2,2] row_mask:0xf bank_mask:0xf
    v_add_f32_dpp v60, v30, v60 quad_perm:[2,2,2,2] row_mask:0xf bank_mask:0xf
    v_add_f32_dpp v48, v19, v48 quad_perm:[3,3,3,3] row_mask:0xf bank_mask:0xf
    v_add_f32_dpp v52, v23, v52 quad_perm:[3,3,3,3] row_mask:0xf bank_mask:0xf
    v_add_f32_dpp v56, v27, v56 quad_perm:[3,3,3,3] row_mask:0xf bank_mask:0xf
    v_add_f32_dpp v60, v31, v60 quad_perm:[3,3,3,3] row_mask:0xf bank_mask:0xf
    v_cvt_pk_bf16_f32 v48, 0, v48
    v_cvt_pk_bf16_f32 v52, 0, v52
    v_cvt_pk_bf16_f32 v56, 0, v56
    v_cvt_pk_bf16_f32 v60, 0, v60
    v_mul_f32 v48, 0x3db504f3, v48
    v_mul_f32 v52, 0x3db504f3, v52
    v_mul_f32 v56, 0x3db504f3, v56
    v_mul_f32 v60, 0x3db504f3, v60
    v_cvt_pk_bf16_f32 v48, 0, v48
    v_cvt_pk_bf16_f32 v52, 0, v52
    v_cvt_pk_bf16_f32 v56, 0, v56
    v_cvt_pk_bf16_f32 v60, 0, v60
    s_waitcnt vmcnt(2)
    buffer_load_dwordx4 v[100:103], v5, s[36:39], s57 offen nt
    v_mfma_f32_16x16x32_bf16 v[16:19], v[64:67], v[12:15], 0
    v_mfma_f32_16x16x32_bf16 v[20:23], v[68:71], v[12:15], 0
    v_mfma_f32_16x16x32_bf16 v[24:27], v[72:75], v[12:15], 0
    v_mfma_f32_16x16x32_bf16 v[28:31], v[76:79], v[12:15], 0
    s_nop 4
    v_mov_b32_dpp v64, v16 quad_perm:[0,0,0,0] row_mask:0xf bank_mask:0xf
    v_mov_b32_dpp v68, v20 quad_perm:[0,0,0,0] row_mask:0xf bank_mask:0xf
    v_mov_b32_dpp v72, v24 quad_perm:[0,0,0,0] row_mask:0xf bank_mask:0xf
    v_mov_b32_dpp v76, v28 quad_perm:[0,0,0,0] row_mask:0xf bank_mask:0xf
    v_add_f32_dpp v64, v17, v64 quad_perm:[1,1,1,1] row_mask:0xf bank_mask:0xf
    v_add_f32_dpp v68, v21, v68 quad_perm:[1,1,1,1] row_mask:0xf bank_mask:0xf
    v_add_f32_dpp v72, v25, v72 quad_perm:[1,1,1,1] row_mask:0xf bank_mask:0xf
    v_add_f32_dpp v76, v29, v76 quad_perm:[1,1,1,1] row_mask:0xf bank_mask:0xf
    v_add_f32_dpp v64, v18, v64 quad_perm:[2,2,2,2] row_mask:0xf bank_mask:0xf
    v_add_f32_dpp v68, v22, v68 quad_perm:[2,2,2,2] row_mask:0xf bank_mask:0xf
    v_add_f32_dpp v72, v26, v72 quad_perm:[2,2,2,2] row_mask:0xf bank_mask:0xf
    v_add_f32_dpp v76, v30, v76 quad_perm:[2,2,2,2] row_mask:0xf bank_mask:0xf
    v_add_f32_dpp v64, v19, v64 quad_perm:[3,3,3,3] row_mask:0xf bank_mask:0xf
    v_add_f32_dpp v68, v23, v68 quad_perm:[3,3,3,3] row_mask:0xf bank_mask:0xf
    v_add_f32_dpp v72, v27, v72 quad_perm:[3,3,3,3] row_mask:0xf bank_mask:0xf
    v_add_f32_dpp v76, v31, v76 quad_perm:[3,3,3,3] row_mask:0xf bank_mask:0xf
    v_cvt_pk_bf16_f32 v64, 0, v64
    v_cvt_pk_bf16_f32 v68, 0, v68
    v_cvt_pk_bf16_f32 v72, 0, v72
    v_cvt_pk_bf16_f32 v76, 0, v76
    v_mul_f32 v64, 0x3db504f3, v64
    v_mul_f32 v68, 0x3db504f3, v68
    v_mul_f32 v72, 0x3db504f3, v72
    v_mul_f32 v76, 0x3db504f3, v76
    v_cvt_pk_bf16_f32 v64, 0, v64
    v_cvt_pk_bf16_f32 v68, 0, v68
    v_cvt_pk_bf16_f32 v72, 0, v72
    v_cvt_pk_bf16_f32 v76, 0, v76
    s_waitcnt vmcnt(2)
    buffer_load_dwordx4 v[104:107], v5, s[36:39], s58 offen nt
    v_mfma_f32_16x16x32_bf16 v[16:19], v[80:83], v[12:15], 0
    v_mfma_f32_16x16x32_bf16 v[20:23], v[84:87], v[12:15], 0
    v_mfma_f32_16x16x32_bf16 v[24:27], v[88:91], v[12:15], 0
    v_mfma_f32_16x16x32_bf16 v[28:31], v[92:95], v[12:15], 0
    s_nop 4
    v_mov_b32_dpp v80, v16 quad_perm:[0,0,0,0] row_mask:0xf bank_mask:0xf
    v_mov_b32_dpp v84, v20 quad_perm:[0,0,0,0] row_mask:0xf bank_mask:0xf
    v_mov_b32_dpp v88, v24 quad_perm:[0,0,0,0] row_mask:0xf bank_mask:0xf
    v_mov_b32_dpp v92, v28 quad_perm:[0,0,0,0] row_mask:0xf bank_mask:0xf
    v_add_f32_dpp v80, v17, v80 quad_perm:[1,1,1,1] row_mask:0xf bank_mask:0xf
    v_add_f32_dpp v84, v21, v84 quad_perm:[1,1,1,1] row_mask:0xf bank_mask:0xf
    v_add_f32_dpp v88, v25, v88 quad_perm:[1,1,1,1] row_mask:0xf bank_mask:0xf
    v_add_f32_dpp v92, v29, v92 quad_perm:[1,1,1,1] row_mask:0xf bank_mask:0xf
    v_add_f32_dpp v80, v18, v80 quad_perm:[2,2,2,2] row_mask:0xf bank_mask:0xf
    v_add_f32_dpp v84, v22, v84 quad_perm:[2,2,2,2] row_mask:0xf bank_mask:0xf
    v_add_f32_dpp v88, v26, v88 quad_perm:[2,2,2,2] row_mask:0xf bank_mask:0xf
    v_add_f32_dpp v92, v30, v92 quad_perm:[2,2,2,2] row_mask:0xf bank_mask:0xf
    v_add_f32_dpp v80, v19, v80 quad_perm:[3,3,3,3] row_mask:0xf bank_mask:0xf
    v_add_f32_dpp v84, v23, v84 quad_perm:[3,3,3,3] row_mask:0xf bank_mask:0xf
    v_add_f32_dpp v88, v27, v88 quad_perm:[3,3,3,3] row_mask:0xf bank_mask:0xf
    v_add_f32_dpp v92, v31, v92 quad_perm:[3,3,3,3] row_mask:0xf bank_mask:0xf
    v_cvt_pk_bf16_f32 v80, 0, v80
    v_cvt_pk_bf16_f32 v84, 0, v84
    v_cvt_pk_bf16_f32 v88, 0, v88
    v_cvt_pk_bf16_f32 v92, 0, v92
    v_mul_f32 v80, 0x3db504f3, v80
    v_mul_f32 v84, 0x3db504f3, v84
    v_mul_f32 v88, 0x3db504f3, v88
    v_mul_f32 v92, 0x3db504f3, v92
    v_cvt_pk_bf16_f32 v80, 0, v80
    v_cvt_pk_bf16_f32 v84, 0, v84
    v_cvt_pk_bf16_f32 v88, 0, v88
    v_cvt_pk_bf16_f32 v92, 0, v92
    s_waitcnt vmcnt(2)
    buffer_load_dwordx4 v[108:111], v5, s[36:39], s59 offen nt
    v_max3_f32 v16, v32, v36, v40
    v_max3_f32 v17, v44, v48, v52
    v_max3_f32 v18, v56, v60, v64
    v_max3_f32 v19, v68, v72, v76
    v_max3_f32 v16, v16, v80, v84
    v_max3_f32 v17, v17, v88, v92
    v_max3_f32 v16, v16, v17, v18
    v_max_f32 v16, v16, v19
    v_mov_b32 v18, v16
    s_nop 1
    v_permlane16_swap_b32 v16, v18
    v_max_f32 v16, v16, v18
    v_mov_b32 v18, v16
    s_nop 1
    v_permlane32_swap_b32 v16, v18
    v_max_f32 v16, v16, v18
    v_mul_f32 v18, s79, v16
    v_fma_f32 v32, v32, s79, -v18
    v_fma_f32 v36, v36, s79, -v18
    v_fma_f32 v40, v40, s79, -v18
    v_fma_f32 v44, v44, s79, -v18
    v_fma_f32 v48, v48, s79, -v18
    v_fma_f32 v52, v52, s79, -v18
    v_fma_f32 v56, v56, s79, -v18
    v_fma_f32 v60, v60, s79, -v18
    v_fma_f32 v64, v64, s79, -v18
    v_fma_f32 v68, v68, s79, -v18
    v_fma_f32 v72, v72, s79, -v18
    v_fma_f32 v76, v76, s79, -v18
    v_fma_f32 v80, v80, s79, -v18
    v_fma_f32 v84, v84, s79, -v18
    v_fma_f32 v88, v88, s79, -v18
    v_fma_f32 v92, v92, s79, -v18
    s_waitcnt vmcnt(2)
    buffer_load_dwordx4 v[112:115], v5, s[36:39], s60 offen nt
    v_exp_f32 v32, v32
    v_exp_f32 v36, v36
    v_exp_f32 v40, v40
    v_exp_f32 v44, v44
    v_exp_f32 v48, v48
    v_exp_f32 v52, v52
    v_exp_f32 v56, v56
    v_exp_f32 v60, v60
    v_exp_f32 v64, v64
    v_exp_f32 v68, v68
    v_exp_f32 v72, v72
    v_exp_f32 v76, v76
    v_exp_f32 v80, v80
    v_exp_f32 v84, v84
    v_exp_f32 v88, v88
    v_exp_f32 v92, v92
    v_add_f32 v20, v32, v48
    v_add_f32 v21, v36, v52
    v_add_f32 v22, v40, v56
    v_add_f32 v23, v44, v60
    v_add_f32 v20, v20, v64
    v_add_f32 v21, v21, v68
    v_add_f32 v22, v22, v72
    v_add_f32 v23, v23, v76
    v_add_f32 v20, v20, v80
    v_add_f32 v21, v21, v84
    v_add_f32 v22, v22, v88
    v_add_f32 v23, v23, v92
    v_add_f32 v20, v20, v21
    v_add_f32 v22, v22, v23
    v_add_f32 v17, v20, v22
    v_mov_b32 v18, v17
    s_nop 1
    v_permlane16_swap_b32 v17, v18
    v_add_f32 v17, v17, v18
    v_mov_b32 v18, v17
    s_nop 1
    v_permlane32_swap_b32 v17, v18
    v_add_f32 v17, v17, v18
    s_lshl_b32 s72, s54, 3
    v_lshl_add_u32 v7, v10, 6, s72
    ds_write_b64 v7, v[16:17] offset:2816
    v_mov_b32 v7, 1
    s_mov_b64 exec, 1
    ds_add_u32 v1, v7 offset:4
    s_mov_b64 exec, -1
    s_waitcnt vmcnt(2)
    buffer_load_dwordx4 v[116:119], v5, s[36:39], s61 offen nt
    v_cvt_pk_bf16_f32 v33, v32, v32
    v_cvt_pk_bf16_f32 v37, v36, v36
    v_cvt_pk_bf16_f32 v41, v40, v40
    v_cvt_pk_bf16_f32 v45, v44, v44
    v_cvt_pk_bf16_f32 v49, v48, v48
    v_cvt_pk_bf16_f32 v53, v52, v52
    v_cvt_pk_bf16_f32 v57, v56, v56
    v_cvt_pk_bf16_f32 v61, v60, v60
    v_cvt_pk_bf16_f32 v65, v64, v64
    v_cvt_pk_bf16_f32 v69, v68, v68
    v_cvt_pk_bf16_f32 v73, v72, v72
    v_cvt_pk_bf16_f32 v77, v76, v76
    v_cvt_pk_bf16_f32 v81, v80, v80
    v_cvt_pk_bf16_f32 v85, v84, v84
    v_cvt_pk_bf16_f32 v89, v88, v88
    v_cvt_pk_bf16_f32 v93, v92, v92
    v_and_b32 v34, v33, v8
    v_and_b32 v35, v33, v9
    v_and_b32 v38, v37, v8
    v_and_b32 v39, v37, v9
    v_and_b32 v42, v41, v8
    v_and_b32 v43, v41, v9
    v_and_b32 v46, v45, v8
    v_and_b32 v47, v45, v9
    v_and_b32 v50, v49, v8
    v_and_b32 v51, v49, v9
    v_and_b32 v54, v53, v8
    v_and_b32 v55, v53, v9
    v_and_b32 v58, v57, v8
    v_and_b32 v59, v57, v9
    v_and_b32 v62, v61, v8
    v_and_b32 v63, v61, v9
    v_and_b32 v66, v65, v8
    v_and_b32 v67, v65, v9
    v_and_b32 v70, v69, v8
    v_and_b32 v71, v69, v9
    v_and_b32 v74, v73, v8
    v_and_b32 v75, v73, v9
    v_and_b32 v78, v77, v8
    v_and_b32 v79, v77, v9
    v_and_b32 v82, v81, v8
    v_and_b32 v83, v81, v9
    v_and_b32 v86, v85, v8
    v_and_b32 v87, v85, v9
    v_and_b32 v90, v89, v8
    v_and_b32 v91, v89, v9
    v_and_b32 v94, v93, v8
    v_and_b32 v95, v93, v9
    ds_read_b32 v30, v1 offset:60
    s_waitcnt lgkmcnt(0)
    v_readfirstlane_b32 s76, v30
    s_waitcnt vmcnt(2)
    buffer_load_dwordx4 v[120:123], v5, s[36:39], s62 offen nt
    v_mfma_f32_16x16x16_bf16 v[16:19], v[34:35], v[96:97], 0
    v_mfma_f32_16x16x16_bf16 v[20:23], v[34:35], v[98:99], 0
    v_mfma_f32_16x16x16_bf16 v[16:19], v[38:39], v[100:101], v[16:19]
    v_mfma_f32_16x16x16_bf16 v[20:23], v[38:39], v[102:103], v[20:23]
    v_mfma_f32_16x16x16_bf16 v[16:19], v[42:43], v[104:105], v[16:19]
    v_mfma_f32_16x16x16_bf16 v[20:23], v[42:43], v[106:107], v[20:23]
    v_mfma_f32_16x16x16_bf16 v[16:19], v[46:47], v[108:109], v[16:19]
    v_mfma_f32_16x16x16_bf16 v[20:23], v[46:47], v[110:111], v[20:23]
    s_cmp_ge_u32 s76, 24
    s_cbranch_scc1 L_bs24
    s_waitcnt vmcnt(2)
L_bs24:
    s_waitcnt vmcnt(3)
    buffer_load_dwordx4 v[124:127], v5, s[36:39], s63 offen nt
    s_cmp_ge_u32 s76, 24
    s_cbranch_scc1 L_bs25
    s_waitcnt vmcnt(2)
L_bs25:
    s_waitcnt vmcnt(3)
    buffer_load_dwordx4 v[128:131], v5, s[36:39], s64 offen nt
    v_mfma_f32_16x16x16_bf16 v[16:19], v[50:51], v[112:113], v[16:19]
    v_mfma_f32_16x16x16_bf16 v[20:23], v[50:51], v[114:115], v[20:23]
    s_cmp_ge_u32 s76, 24
    s_cbranch_scc1 L_bs26
    s_waitcnt vmcnt(2)
L_bs26:
    s_waitcnt vmcnt(3)
    buffer_load_dwordx4 v[132:135], v5, s[36:39], s65 offen nt
    v_mfma_f32_16x16x16_bf16 v[16:19], v[54:55], v[116:117], v[16:19]
    v_mfma_f32_16x16x16_bf16 v[20:23], v[54:55], v[118:119], v[20:23]
    s_cmp_ge_u32 s76, 24
    s_cbranch_scc1 L_bs27
    s_waitcnt vmcnt(2)
L_bs27:
    s_waitcnt vmcnt(3)
    buffer_load_dwordx4 v[136:139], v5, s[36:39], s66 offen nt
    v_mfma_f32_16x16x16_bf16 v[16:19], v[58:59], v[120:121], v[16:19]
    v_mfma_f32_16x16x16_bf16 v[20:23], v[58:59], v[122:123], v[20:23]
    s_lshl_b32 s72, s54, 13
    s_lshl_b32 s57, s77, 17
    s_add_u32 s57, s57, s72
    s_lshl_b32 s74, s31, 7
    s_add_u32 s57, s57, s74
    s_add_u32 s58, s57, 0x10000
    s_mul_i32 s72, s54, 2080
    s_add_u32 s72, s72, 65536
    v_add_u32 v24, s72, v5
    v_mul_u32_u24 v25, 4160, v11
    v_bfe_u32 v7, v0, 2, 1
    v_lshl_add_u32 v25, v7, 10, v25
    v_lshrrev_b32 v7, 3, v0
    v_lshl_add_u32 v25, v7, 4, v25
    s_lshl_b32 s72, s54, 7
    s_add_u32 s72, s72, 65536
    v_add_u32 v25, s72, v25
    s_lshl_b32 s72, s54, 4
    v_lshl_add_u32 v26, v3, 2, s72
    s_lshl_b32 s72, s77, 3
    s_add_u32 s72, s72, s31
    s_lshl_b32 s72, s72, 11
    s_lshl_b32 s74, s54, 8
    s_add_u32 s72, s72, s74
    s_add_u32 s72, s72, 524288
    v_lshrrev_b32 v7, 2, v0
    v_lshl_add_u32 v27, v7, 4, s72
    v_mov_b32 v28, 1
    s_cmp_ge_u32 s76, 24
    s_cbranch_scc1 L_bs28
    s_waitcnt vmcnt(2)
L_bs28:
    s_waitcnt vmcnt(3)
    buffer_load_dwordx4 v[140:143], v5, s[36:39], s67 offen nt
    v_mfma_f32_16x16x16_bf16 v[16:19], v[62:63], v[124:125], v[16:19]
    v_mfma_f32_16x16x16_bf16 v[20:23], v[62:63], v[126:127], v[20:23]
    s_cmp_ge_u32 s76, 24
    s_cbranch_scc1 L_bs29
    s_waitcnt vmcnt(2)
L_bs29:
    s_waitcnt vmcnt(3)
    buffer_load_dwordx4 v[144:147], v5, s[36:39], s68 offen nt
    v_mfma_f32_16x16x16_bf16 v[16:19], v[66:67], v[128:129], v[16:19]
    v_mfma_f32_16x16x16_bf16 v[20:23], v[66:67], v[130:131], v[20:23]
    s_cmp_ge_u32 s76, 24
    s_cbranch_scc1 L_bs30
    s_waitcnt vmcnt(2)
L_bs30:
    s_waitcnt vmcnt(3)
    buffer_load_dwordx4 v[148:151], v5, s[36:39], s69 offen nt
    v_mfma_f32_16x16x16_bf16 v[16:19], v[70:71], v[132:133], v[16:19]
    v_mfma_f32_16x16x16_bf16 v[20:23], v[70:71], v[134:135], v[20:23]
    s_cmp_ge_u32 s76, 24
    s_cbranch_scc1 L_bs31
    s_waitcnt vmcnt(2)
L_bs31:
    s_waitcnt vmcnt(3)
    buffer_load_dwordx4 v[152:155], v5, s[36:39], s70 offen nt
    v_mfma_f32_16x16x16_bf16 v[16:19], v[74:75], v[136:137], v[16:19]
    v_mfma_f32_16x16x16_bf16 v[20:23], v[74:75], v[138:139], v[20:23]
    s_cmp_ge_u32 s76, 24
    s_cbranch_scc1 L_bs32
    s_waitcnt vmcnt(2)
L_bs32:
    s_waitcnt vmcnt(3)
    buffer_load_dwordx4 v[156:159], v5, s[36:39], s71 offen nt
    v_mfma_f32_16x16x16_bf16 v[16:19], v[78:79], v[140:141], v[16:19]
    v_mfma_f32_16x16x16_bf16 v[20:23], v[78:79], v[142:143], v[20:23]
    s_cmp_ge_u32 s76, 24
    s_cbranch_scc1 L_bs33
    s_waitcnt vmcnt(1)
L_bs33:
    s_waitcnt vmcnt(3)
    v_mfma_f32_16x16x16_bf16 v[16:19], v[82:83], v[144:145], v[16:19]
    v_mfma_f32_16x16x16_bf16 v[20:23], v[82:83], v[146:147], v[20:23]
    s_add_u32 m0, s73, 49152
    s_nop 0
    buffer_load_dwordx4 v6, s[40:43], s57 offen nt lds
    s_branch L_lw2
L_lwr2:
    s_sleep 1
L_lw2:
    ds_read_b32 v7, v1 offset:12
    s_add_u32 s53, s53, 1
    s_cmp_gt_u32 s53, 4194304
    s_cbranch_scc1 L_end
    s_waitcnt lgkmcnt(0)
    v_cmp_ne_u32 vcc, 3, v7
    s_cbranch_vccnz L_lwr2
    ds_read_b32 v12, v26 offset:3072
    s_cmp_ge_u32 s76, 24
    s_cbranch_scc1 L_bs34
    s_waitcnt vmcnt(1)
L_bs34:
    s_waitcnt vmcnt(3)
    v_mfma_f32_16x16x16_bf16 v[16:19], v[86:87], v[148:149], v[16:19]
    v_mfma_f32_16x16x16_bf16 v[20:23], v[86:87], v[150:151], v[20:23]
    s_add_u32 m0, s73, 57344
    s_nop 0
    buffer_load_dwordx4 v6, s[40:43], s58 offen nt lds
    s_waitcnt vmcnt(3)
    v_mfma_f32_16x16x16_bf16 v[16:19], v[90:91], v[152:153], v[16:19]
    v_mfma_f32_16x16x16_bf16 v[20:23], v[90:91], v[154:155], v[20:23]
    s_waitcnt vmcnt(2)
    v_mfma_f32_16x16x16_bf16 v[16:19], v[94:95], v[156:157], v[16:19]
    v_mfma_f32_16x16x16_bf16 v[20:23], v[94:95], v[158:159], v[20:23]
    s_waitcnt lgkmcnt(0)
    s_nop 5
    v_pk_mul_f32 v[16:17], v[16:17], v[12:13] op_sel_hi:[1,0]
    v_pk_mul_f32 v[18:19], v[18:19], v[12:13] op_sel_hi:[1,0]
    v_pk_mul_f32 v[20:21], v[20:21], v[12:13] op_sel_hi:[1,0]
    v_pk_mul_f32 v[22:23], v[22:23], v[12:13] op_sel_hi:[1,0]
    ds_write_b128 v24, v[16:19]
    ds_write_b128 v24, v[20:23] offset:1024
    s_mov_b64 exec, 1
    ds_add_u32 v1, v28 offset:20
    s_mov_b64 exec, -1
L_orr:
    ds_read_b32 v7, v1 offset:20
    ds_read_b128 v[32:35], v25
    ds_read_b128 v[36:39], v25 offset:2080
    s_add_u32 s53, s53, 1
    s_cmp_gt_u32 s53, 4194304
    s_cbranch_scc1 L_end
    s_waitcnt lgkmcnt(2)
    v_cmp_ne_u32 vcc, 8, v7
    s_cbranch_vccnz L_orr
    s_waitcnt lgkmcnt(0)
    v_pk_add_f32 v[32:33], v[32:33], v[36:37]
    v_pk_add_f32 v[34:35], v[34:35], v[38:39]
    s_nop 0
    v_add_f32_dpp v32, v32, v32 quad_perm:[1,0,3,2] row_mask:0xf bank_mask:0xf
    v_add_f32_dpp v33, v33, v33 quad_perm:[1,0,3,2] row_mask:0xf bank_mask:0xf
    v_add_f32_dpp v34, v34, v34 quad_perm:[1,0,3,2] row_mask:0xf bank_mask:0xf
    v_add_f32_dpp v35, v35, v35 quad_perm:[1,0,3,2] row_mask:0xf bank_mask:0xf
    v_add_f32_dpp v32, v32, v32 quad_perm:[2,3,0,1] row_mask:0xf bank_mask:0xf
    v_add_f32_dpp v33, v33, v33 quad_perm:[2,3,0,1] row_mask:0xf bank_mask:0xf
    v_add_f32_dpp v34, v34, v34 quad_perm:[2,3,0,1] row_mask:0xf bank_mask:0xf
    v_add_f32_dpp v35, v35, v35 quad_perm:[2,3,0,1] row_mask:0xf bank_mask:0xf
    s_mov_b32 exec_lo, 0x11111111
    s_mov_b32 exec_hi, 0x11111111
    v_and_or_b32 v32, v32, v2, s48
    v_and_or_b32 v33, v33, v2, s49
    v_and_or_b32 v34, v34, v2, s50
    v_and_or_b32 v35, v35, v2, s51
    s_cmp_eq_u32 s78, 1
    s_cbranch_scc0 L_ps3
    global_store_dwordx4 v27, v[32:35], s[26:27] offset:0
L_pd3:
    s_mov_b64 exec, 1
    ds_add_u32 v1, v28 offset:44
    s_waitcnt vmcnt(1)
    ds_add_u32 v1, v28 offset:24
L_kvdone:
    s_endpgm
.p2align 12
L_help:
    s_setprio 3
    v_lshrrev_b32 v3, 4, v0
    v_and_b32 v4, 15, v0
    v_lshlrev_b32 v5, 4, v4
    s_lshl_b32 s72, s30, 8
    v_add_u32 v32, s72, v5
    v_add_u32 v33, 256, v32
    v_add_u32 v34, 512, v32
    v_add_u32 v35, 768, v32
    v_and_b32 v33, 0x3ff, v33
    v_and_b32 v34, 0x3ff, v34
    v_and_b32 v35, 0x3ff, v35
    v_lshl_add_u32 v32, v3, 10, v32
    v_lshl_add_u32 v33, v3, 10, v33
    v_lshl_add_u32 v34, v3, 10, v34
    v_lshl_add_u32 v35, v3, 10, v35
    s_getreg_b32 s66, hwreg(HW_REG_XCC_ID)
    s_and_b32 s66, s66, 15
    s_add_u32 s66, s66, 1
    s_lshl_b32 s62, s28, 5
    s_add_u32 s72, s62, s29
    v_mov_b32 v12, s72
    v_mov_b32 v14, s66
    s_cmp_lt_u32 s3, 2
    s_waitcnt lgkmcnt(0)
    s_cbranch_scc0 L_nx
    global_load_dwordx4 v[16:19], v32, s[4:5]
    global_load_dwordx4 v[20:23], v33, s[4:5]
    global_load_dwordx4 v[24:27], v34, s[4:5]
    global_load_dwordx4 v[28:31], v35, s[4:5]
    s_branch L_nox
L_nx:
    s_mov_b64 exec, 1
    global_store_byte v12, v14, s[24:25]
    s_mov_b64 exec, -1
L_nox:
    s_lshl_b32 s77, s28, 2
    s_add_u32 s77, s77, s30
    s_mov_b32 s53, 0
    v_mov_b32 v1, 2560
    v_mov_b32 v2, 0xffffff00
    v_lshrrev_b32 v3, 4, v0
    v_and_b32 v11, 3, v0
    v_bfe_u32 v10, v0, 2, 2
    v_mov_b32 v40, 0
    v_mov_b32 v41, 0
    v_mov_b32 v42, 0
    v_mov_b32 v43, 0
    ds_write_b128 v1, v[40:43] offset:0
    ds_write_b128 v1, v[40:43] offset:16
    ds_write_b128 v1, v[40:43] offset:32
    ds_write_b128 v1, v[40:43] offset:48
    s_mov_b32 s55, s76
    s_mov_b32 s54, s75
    v_lshl_add_u32 v15, v3, 3, v10
    v_lshlrev_b32 v15, 7, v15
    v_lshl_add_u32 v15, v11, 3, v15
    s_mul_i32 s66, s66, 0x01010101
    v_lshl_add_u32 v13, v0, 2, s62
    s_waitcnt lgkmcnt(0)
    s_load_dword s52, s[26:27], 0
    s_barrier
    s_cmp_lt_u32 s3, 2
    s_cbranch_scc1 L_h01
    s_waitcnt lgkmcnt(0)
    s_add_u32 s52, s52, 1
    s_and_b32 s48, s52, 0xff
    s_xor_b32 s49, s48, 0x55
    s_xor_b32 s50, s48, 0xaa
    s_xor_b32 s51, s48, 0xff
    s_cmp_eq_u32 s3, 2
    s_cbranch_scc1 L_h2
    v_mov_b32 v7, 1
    s_mov_b64 exec, 1
    ds_add_u32 v1, v7 offset:12
    s_mov_b64 exec, -1
    s_mul_i32 s67, s48, 0x01010101
    s_xor_b32 s67, s67, 0xffaa5500
    s_lshl_b32 s72, s28, 7
    s_add_u32 s72, s72, 12288
    v_lshl_add_u32 v13, v0, 2, s72
    s_lshl_b32 s73, s29, 2
    s_add_u32 s72, s72, s73
    v_mov_b32 v12, s72
    v_mov_b32 v14, s67
    s_branch L_lw4
L_lwr4:
    s_sleep 2
L_lw4:
    ds_read_b32 v7, v1 offset:56
    s_add_u32 s53, s53, 1
    s_cmp_gt_u32 s53, 4194304
    s_cbranch_scc1 L_end
    s_waitcnt lgkmcnt(0)
    v_cmp_gt_u32 vcc, 8, v7
    s_cbranch_vccnz L_lwr4
    s_mov_b32 exec_hi, 0
    global_load_dword v16, v13, s[26:27] offset:0 sc1
    s_mov_b32 exec_lo, 1
    global_store_dword v12, v14, s[26:27] offset:0
    s_mov_b32 exec_lo, -1
    s_waitcnt vmcnt(1)
    v_cmp_eq_u32 vcc, s67, v16
    s_nop 0
    s_bcnt1_i32_b64 s72, vcc
    s_mov_b64 exec, -1
    v_mov_b32 v16, s72
    ds_write_b32 v1, v16 offset:60
    s_branch L_tail
L_h2:
    s_mov_b64 exec, 0xff
    s_mov_b32 s78, 2
    s_mov_b32 s67, 0
L_xr:
    s_add_u32 s67, s67, 1
    s_cmp_gt_u32 s67, 24
    s_cbranch_scc1 L_xe
    global_load_dword v14, v13, s[24:25] sc1
    s_waitcnt vmcnt(0)
    v_cmp_ne_u32 vcc, s66, v14
    s_cbranch_vccnz L_xr
    s_mov_b32 s78, 1
L_xe:
    s_mov_b64 exec, -1
    v_mov_b32 v16, s78
    ds_write_b32 v1, v16 offset:8
    s_branch L_tail
L_h01:
    s_waitcnt vmcnt(0)
    v_lshlrev_b32 v32, 16, v16
    v_and_b32 v33, 0xffff0000, v16
    v_lshlrev_b32 v34, 16, v17
    v_and_b32 v35, 0xffff0000, v17
    v_lshlrev_b32 v36, 16, v18
    v_and_b32 v37, 0xffff0000, v18
    v_lshlrev_b32 v38, 16, v19
    v_and_b32 v39, 0xffff0000, v19
    v_lshlrev_b32 v40, 16, v20
    v_and_b32 v41, 0xffff0000, v20
    v_lshlrev_b32 v42, 16, v21
    v_and_b32 v43, 0xffff0000, v21
    v_lshlrev_b32 v44, 16, v22
    v_and_b32 v45, 0xffff0000, v22
    v_lshlrev_b32 v46, 16, v23
    v_and_b32 v47, 0xffff0000, v23
    v_lshlrev_b32 v48, 16, v24
    v_and_b32 v49, 0xffff0000, v24
    v_lshlrev_b32 v50, 16, v25
    v_and_b32 v51, 0xffff0000, v25
    v_lshlrev_b32 v52, 16, v26
    v_and_b32 v53, 0xffff0000, v26
    v_lshlrev_b32 v54, 16, v27
    v_and_b32 v55, 0xffff0000, v27
    v_lshlrev_b32 v56, 16, v28
    v_and_b32 v57, 0xffff0000, v28
    v_lshlrev_b32 v58, 16, v29
    v_and_b32 v59, 0xffff0000, v29
    v_lshlrev_b32 v60, 16, v30
    v_and_b32 v61, 0xffff0000, v30
    v_lshlrev_b32 v62, 16, v31
    v_and_b32 v63, 0xffff0000, v31
    v_pk_add_f32 v[64:65], v[32:33], v[34:35]
    v_pk_add_f32 v[66:67], v[36:37], v[38:39]
    v_pk_add_f32 v[68:69], v[40:41], v[42:43]
    v_pk_add_f32 v[70:71], v[44:45], v[46:47]
    v_pk_add_f32 v[72:73], v[48:49], v[50:51]
    v_pk_add_f32 v[74:75], v[52:53], v[54:55]
    v_pk_add_f32 v[76:77], v[56:57], v[58:59]
    v_pk_add_f32 v[78:79], v[60:61], v[62:63]
    v_pk_add_f32 v[64:65], v[64:65], v[72:73]
    v_pk_add_f32 v[66:67], v[66:67], v[74:75]
    v_pk_add_f32 v[68:69], v[68:69], v[76:77]
    v_pk_add_f32 v[70:71], v[70:71], v[78:79]
    v_pk_add_f32 v[64:65], v[64:65], v[68:69]
    v_pk_add_f32 v[66:67], v[66:67], v[70:71]
    v_pk_add_f32 v[64:65], v[64:65], v[66:67]
    v_add_f32 v12, v64, v65
    s_nop 1
    v_add_f32_dpp v12, v12, v12 row_ror:8 row_mask:0xf bank_mask:0xf
    s_nop 1
    v_add_f32_dpp v12, v12, v12 row_ror:4 row_mask:0xf bank_mask:0xf
    s_nop 1
    v_add_f32_dpp v12, v12, v12 row_ror:2 row_mask:0xf bank_mask:0xf
    s_nop 1
    v_add_f32_dpp v12, v12, v12 row_ror:1 row_mask:0xf bank_mask:0xf
    v_mul_f32 v12, 0x3b000000, v12
    v_pk_add_f32 v[64:65], v[32:33], v[12:13] op_sel_hi:[1,0] neg_lo:[0,1] neg_hi:[0,1]
    v_pk_add_f32 v[66:67], v[34:35], v[12:13] op_sel_hi:[1,0] neg_lo:[0,1] neg_hi:[0,1]
    v_pk_add_f32 v[68:69], v[36:37], v[12:13] op_sel_hi:[1,0] neg_lo:[0,1] neg_hi:[0,1]
    v_pk_add_f32 v[70:71], v[38:39], v[12:13] op_sel_hi:[1,0] neg_lo:[0,1] neg_hi:[0,1]
    v_pk_add_f32 v[72:73], v[40:41], v[12:13] op_sel_hi:[1,0] neg_lo:[0,1] neg_hi:[0,1]
    v_pk_add_f32 v[74:75], v[42:43], v[12:13] op_sel_hi:[1,0] neg_lo:[0,1] neg_hi:[0,1]
    v_pk_add_f32 v[76:77], v[44:45], v[12:13] op_sel_hi:[1,0] neg_lo:[0,1] neg_hi:[0,1]
    v_pk_add_f32 v[78:79], v[46:47], v[12:13] op_sel_hi:[1,0] neg_lo:[0,1] neg_hi:[0,1]
    v_pk_add_f32 v[80:81], v[48:49], v[12:13] op_sel_hi:[1,0] neg_lo:[0,1] neg_hi:[0,1]
    v_pk_add_f32 v[82:83], v[50:51], v[12:13] op_sel_hi:[1,0] neg_lo:[0,1] neg_hi:[0,1]
    v_pk_add_f32 v[84:85], v[52:53], v[12:13] op_sel_hi:[1,0] neg_lo:[0,1] neg_hi:[0,1]
    v_pk_add_f32 v[86:87], v[54:55], v[12:13] op_sel_hi:[1,0] neg_lo:[0,1] neg_hi:[0,1]
    v_pk_add_f32 v[88:89], v[56:57], v[12:13] op_sel_hi:[1,0] neg_lo:[0,1] neg_hi:[0,1]
    v_pk_add_f32 v[90:91], v[58:59], v[12:13] op_sel_hi:[1,0] neg_lo:[0,1] neg_hi:[0,1]
    v_pk_add_f32 v[92:93], v[60:61], v[12:13] op_sel_hi:[1,0] neg_lo:[0,1] neg_hi:[0,1]
    v_pk_add_f32 v[94:95], v[62:63], v[12:13] op_sel_hi:[1,0] neg_lo:[0,1] neg_hi:[0,1]
    v_pk_mul_f32 v[96:97], v[64:65], v[64:65]
    v_pk_mul_f32 v[98:99], v[66:67], v[66:67]
    v_pk_mul_f32 v[100:101], v[68:69], v[68:69]
    v_pk_mul_f32 v[102:103], v[70:71], v[70:71]
    v_pk_fma_f32 v[96:97], v[72:73], v[72:73], v[96:97]
    v_pk_fma_f32 v[98:99], v[74:75], v[74:75], v[98:99]
    v_pk_fma_f32 v[100:101], v[76:77], v[76:77], v[100:101]
    v_pk_fma_f32 v[102:103], v[78:79], v[78:79], v[102:103]
    v_pk_fma_f32 v[96:97], v[80:81], v[80:81], v[96:97]
    v_pk_fma_f32 v[98:99], v[82:83], v[82:83], v[98:99]
    v_pk_fma_f32 v[100:101], v[84:85], v[84:85], v[100:101]
    v_pk_fma_f32 v[102:103], v[86:87], v[86:87], v[102:103]
    v_pk_fma_f32 v[96:97], v[88:89], v[88:89], v[96:97]
    v_pk_fma_f32 v[98:99], v[90:91], v[90:91], v[98:99]
    v_pk_fma_f32 v[100:101], v[92:93], v[92:93], v[100:101]
    v_pk_fma_f32 v[102:103], v[94:95], v[94:95], v[102:103]
    v_pk_add_f32 v[96:97], v[96:97], v[98:99]
    v_pk_add_f32 v[100:101], v[100:101], v[102:103]
    v_pk_add_f32 v[96:97], v[96:97], v[100:101]
    v_add_f32 v14, v96, v97
    s_nop 1
    v_add_f32_dpp v14, v14, v14 row_ror:8 row_mask:0xf bank_mask:0xf
    s_nop 1
    v_add_f32_dpp v14, v14, v14 row_ror:4 row_mask:0xf bank_mask:0xf
    s_nop 1
    v_add_f32_dpp v14, v14, v14 row_ror:2 row_mask:0xf bank_mask:0xf
    s_nop 1
    v_add_f32_dpp v14, v14, v14 row_ror:1 row_mask:0xf bank_mask:0xf
    v_mul_f32 v14, 0x3b000000, v14
    v_cvt_pk_bf16_f32 v12, 0, v12
    v_cvt_pk_bf16_f32 v14, 0, v14
    v_add_f32 v14, 0x3727c5ac, v14
    v_cvt_pk_bf16_f32 v14, 0, v14
    v_sqrt_f32 v14, v14
    s_nop 0
    v_cvt_pk_bf16_f32 v14, 0, v14
    v_rcp_f32 v14, v14
    v_pk_add_f32 v[64:65], v[32:33], v[12:13] op_sel_hi:[1,0] neg_lo:[0,1] neg_hi:[0,1]
    v_pk_add_f32 v[66:67], v[34:35], v[12:13] op_sel_hi:[1,0] neg_lo:[0,1] neg_hi:[0,1]
    v_pk_add_f32 v[68:69], v[36:37], v[12:13] op_sel_hi:[1,0] neg_lo:[0,1] neg_hi:[0,1]
    v_pk_add_f32 v[70:71], v[38:39], v[12:13] op_sel_hi:[1,0] neg_lo:[0,1] neg_hi:[0,1]
    v_cvt_pk_bf16_f32 v16, v64, v65
    v_cvt_pk_bf16_f32 v17, v66, v67
    v_cvt_pk_bf16_f32 v18, v68, v69
    v_cvt_pk_bf16_f32 v19, v70, v71
    v_lshlrev_b32 v64, 16, v16
    v_and_b32 v65, 0xffff0000, v16
    v_lshlrev_b32 v66, 16, v17
    v_and_b32 v67, 0xffff0000, v17
    v_lshlrev_b32 v68, 16, v18
    v_and_b32 v69, 0xffff0000, v18
    v_lshlrev_b32 v70, 16, v19
    v_and_b32 v71, 0xffff0000, v19
    v_pk_mul_f32 v[64:65], v[64:65], v[14:15] op_sel_hi:[1,0]
    v_pk_mul_f32 v[66:67], v[66:67], v[14:15] op_sel_hi:[1,0]
    v_pk_mul_f32 v[68:69], v[68:69], v[14:15] op_sel_hi:[1,0]
    v_pk_mul_f32 v[70:71], v[70:71], v[14:15] op_sel_hi:[1,0]
    v_cvt_pk_bf16_f32 v16, v64, v65
    v_cvt_pk_bf16_f32 v17, v66, v67
    v_cvt_pk_bf16_f32 v18, v68, v69
    v_cvt_pk_bf16_f32 v19, v70, v71
    s_mul_i32 s72, s3, 0x500
    v_mul_u32_u24 v5, 320, v3
    v_lshl_add_u32 v5, v4, 4, v5
    v_add_u32 v5, s72, v5
    ds_write_b128 v5, v[16:19] offset:0
    v_mul_u32_u24 v5, 320, v11
    v_lshl_add_u32 v5, v3, 4, v5
    s_waitcnt lgkmcnt(0)
    s_add_u32 s52, s52, 1
    s_and_b32 s48, s52, 0xff
    s_xor_b32 s49, s48, 0x55
    s_xor_b32 s50, s48, 0xaa
    s_xor_b32 s51, s48, 0xff
    s_cmp_eq_u32 s3, 0
    s_cbranch_scc0 L_hf
    ds_read_b128 v[32:35], v5 offset:0
    ds_read_b128 v[36:39], v5 offset:64
    ds_read_b128 v[40:43], v5 offset:128
    ds_read_b128 v[44:47], v5 offset:192
    s_lshl_b32 s72, s28, 15
    s_lshl_b32 s73, s30, 11
    s_add_u32 s72, s72, s73
    s_lshl_b32 s73, s31, 8
    s_add_u32 s72, s72, s73
    s_add_u32 s72, s72, 1048576
    v_lshlrev_b32 v5, 13, v11
    v_lshl_add_u32 v5, v3, 4, v5
    v_add_u32 v5, s72, v5
    s_branch L_lw5
L_lwr5:
    s_sleep 1
L_lw5:
    ds_read_b32 v7, v1 offset:32
    s_add_u32 s53, s53, 1
    s_cmp_gt_u32 s53, 4194304
    s_cbranch_scc1 L_end
    s_waitcnt lgkmcnt(0)
    v_cmp_ne_u32 vcc, 8, v7
    s_cbranch_vccnz L_lwr5
    ds_read_b64_tr_b16 v[96:97], v15 offset:8192
    ds_read_b64_tr_b16 v[98:99], v15 offset:8704
    ds_read_b64_tr_b16 v[100:101], v15 offset:12288
    ds_read_b64_tr_b16 v[102:103], v15 offset:12800
    ds_read_b64_tr_b16 v[104:105], v15 offset:16384
    ds_read_b64_tr_b16 v[106:107], v15 offset:16896
    ds_read_b64_tr_b16 v[108:109], v15 offset:20480
    ds_read_b64_tr_b16 v[110:111], v15 offset:20992
    ds_read_b64_tr_b16 v[112:113], v15 offset:8224
    ds_read_b64_tr_b16 v[114:115], v15 offset:8736
    ds_read_b64_tr_b16 v[116:117], v15 offset:12320
    ds_read_b64_tr_b16 v[118:119], v15 offset:12832
    ds_read_b64_tr_b16 v[120:121], v15 offset:16416
    ds_read_b64_tr_b16 v[122:123], v15 offset:16928
    ds_read_b64_tr_b16 v[124:125], v15 offset:20512
    ds_read_b64_tr_b16 v[126:127], v15 offset:21024
    ds_read_b64_tr_b16 v[128:129], v15 offset:8256
    ds_read_b64_tr_b16 v[130:131], v15 offset:8768
    ds_read_b64_tr_b16 v[132:133], v15 offset:12352
    ds_read_b64_tr_b16 v[134:135], v15 offset:12864
    ds_read_b64_tr_b16 v[136:137], v15 offset:16448
    ds_read_b64_tr_b16 v[138:139], v15 offset:16960
    ds_read_b64_tr_b16 v[140:141], v15 offset:20544
    ds_read_b64_tr_b16 v[142:143], v15 offset:21056
    ds_read_b64_tr_b16 v[144:145], v15 offset:8288
    ds_read_b64_tr_b16 v[146:147], v15 offset:8800
    ds_read_b64_tr_b16 v[148:149], v15 offset:12384
    ds_read_b64_tr_b16 v[150:151], v15 offset:12896
    ds_read_b64_tr_b16 v[152:153], v15 offset:16480
    ds_read_b64_tr_b16 v[154:155], v15 offset:16992
    ds_read_b64_tr_b16 v[156:157], v15 offset:20576
    ds_read_b64_tr_b16 v[158:159], v15 offset:21088
    s_waitcnt lgkmcnt(0)
    v_mfma_f32_16x16x32_bf16 v[64:67], v[96:99], v[32:35], 0
    v_mfma_f32_16x16x32_bf16 v[68:71], v[112:115], v[32:35], 0
    v_mfma_f32_16x16x32_bf16 v[72:75], v[128:131], v[32:35], 0
    v_mfma_f32_16x16x32_bf16 v[76:79], v[144:147], v[32:35], 0
    v_mfma_f32_16x16x32_bf16 v[64:67], v[100:103], v[36:39], v[64:67]
    v_mfma_f32_16x16x32_bf16 v[68:71], v[116:119], v[36:39], v[68:71]
    v_mfma_f32_16x16x32_bf16 v[72:75], v[132:135], v[36:39], v[72:75]
    v_mfma_f32_16x16x32_bf16 v[76:79], v[148:151], v[36:39], v[76:79]
    v_mfma_f32_16x16x32_bf16 v[64:67], v[104:107], v[40:43], v[64:67]
    v_mfma_f32_16x16x32_bf16 v[68:71], v[120:123], v[40:43], v[68:71]
    v_mfma_f32_16x16x32_bf16 v[72:75], v[136:139], v[40:43], v[72:75]
    v_mfma_f32_16x16x32_bf16 v[76:79], v[152:155], v[40:43], v[76:79]
    v_mfma_f32_16x16x32_bf16 v[64:67], v[108:111], v[44:47], v[64:67]
    v_mfma_f32_16x16x32_bf16 v[68:71], v[124:127], v[44:47], v[68:71]
    v_mfma_f32_16x16x32_bf16 v[72:75], v[140:143], v[44:47], v[72:75]
    v_mfma_f32_16x16x32_bf16 v[76:79], v[156:159], v[44:47], v[76:79]
    s_lshl_b32 s72, s77, 13
    s_add_u32 s72, s72, 1052672
    v_lshlrev_b32 v8, 9, v10
    v_lshl_add_u32 v8, v3, 7, v8
    v_lshl_add_u32 v8, v11, 5, v8
    v_add_u32 v8, s72, v8
    s_branch L_lw6
L_lwr6:
    s_sleep 1
L_lw6:
    ds_read_b32 v7, v1 offset:8
    s_add_u32 s53, s53, 1
    s_cmp_gt_u32 s53, 4194304
    s_cbranch_scc1 L_end
    s_waitcnt lgkmcnt(0)
    v_cmp_eq_u32 vcc, 0, v7
    s_cbranch_vccnz L_lwr6
    v_readfirstlane_b32 s78, v7
    v_and_or_b32 v64, v64, v2, s48
    v_and_or_b32 v65, v65, v2, s49
    v_and_or_b32 v66, v66, v2, s50
    v_and_or_b32 v67, v67, v2, s51
    v_and_or_b32 v68, v68, v2, s48
    v_and_or_b32 v69, v69, v2, s49
    v_and_or_b32 v70, v70, v2, s50
    v_and_or_b32 v71, v71, v2, s51
    v_and_or_b32 v72, v72, v2, s48
    v_and_or_b32 v73, v73, v2, s49
    v_and_or_b32 v74, v74, v2, s50
    v_and_or_b32 v75, v75, v2, s51
    v_and_or_b32 v76, v76, v2, s48
    v_and_or_b32 v77, v77, v2, s49
    v_and_or_b32 v78, v78, v2, s50
    v_and_or_b32 v79, v79, v2, s51
    s_mov_b32 exec_lo, 0x000f000f
    s_mov_b32 exec_hi, 0x000f000f
    s_cmp_eq_u32 s78, 1
    s_cbranch_scc0 L_ps7
    global_store_dwordx4 v5, v[64:67], s[26:27] offset:0
    global_store_dwordx4 v5, v[68:71], s[26:27] offset:64
    global_store_dwordx4 v5, v[72:75], s[26:27] offset:128
    global_store_dwordx4 v5, v[76:79], s[26:27] offset:192
L_pd7:
    s_mov_b64 exec, -1
    s_sleep 48
    s_branch L_poll8
L_pollr8:
    s_sleep 4
L_poll8:
    global_load_dwordx4 v[32:35], v8, s[26:27] offset:-4096 sc1
    global_load_dwordx4 v[36:39], v8, s[26:27] offset:-4080 sc1
    global_load_dwordx4 v[40:43], v8, s[26:27] offset:-2048 sc1
    global_load_dwordx4 v[44:47], v8, s[26:27] offset:-2032 sc1
    global_load_dwordx4 v[48:51], v8, s[26:27] offset:0 sc1
    global_load_dwordx4 v[52:55], v8, s[26:27] offset:16 sc1
    global_load_dwordx4 v[56:59], v8, s[26:27] offset:2048 sc1
    global_load_dwordx4 v[60:63], v8, s[26:27] offset:2064 sc1
    s_add_u32 s53, s53, 1
    s_cmp_gt_u32 s53, 4194304
    s_cbranch_scc1 L_end
    s_waitcnt vmcnt(7)
    v_xor_b32 v6, s48, v32
    v_xor_b32 v7, s49, v33
    v_bitop3_b32 v6, v6, v34, s50 bitop3:0xf6
    v_bitop3_b32 v7, v7, v35, s51 bitop3:0xf6
    s_waitcnt vmcnt(6)
    v_bitop3_b32 v6, v6, v36, s48 bitop3:0xf6
    v_bitop3_b32 v7, v7, v37, s49 bitop3:0xf6
    v_bitop3_b32 v6, v6, v38, s50 bitop3:0xf6
    v_bitop3_b32 v7, v7, v39, s51 bitop3:0xf6
    s_waitcnt vmcnt(5)
    v_bitop3_b32 v6, v6, v40, s48 bitop3:0xf6
    v_bitop3_b32 v7, v7, v41, s49 bitop3:0xf6
    v_bitop3_b32 v6, v6, v42, s50 bitop3:0xf6
    v_bitop3_b32 v7, v7, v43, s51 bitop3:0xf6
    s_waitcnt vmcnt(4)
    v_bitop3_b32 v6, v6, v44, s48 bitop3:0xf6
    v_bitop3_b32 v7, v7, v45, s49 bitop3:0xf6
    v_bitop3_b32 v6, v6, v46, s50 bitop3:0xf6
    v_bitop3_b32 v7, v7, v47, s51 bitop3:0xf6
    s_waitcnt vmcnt(3)
    v_bitop3_b32 v6, v6, v48, s48 bitop3:0xf6
    v_bitop3_b32 v7, v7, v49, s49 bitop3:0xf6
    v_bitop3_b32 v6, v6, v50, s50 bitop3:0xf6
    v_bitop3_b32 v7, v7, v51, s51 bitop3:0xf6
    s_waitcnt vmcnt(2)
    v_bitop3_b32 v6, v6, v52, s48 bitop3:0xf6
    v_bitop3_b32 v7, v7, v53, s49 bitop3:0xf6
    v_bitop3_b32 v6, v6, v54, s50 bitop3:0xf6
    v_bitop3_b32 v7, v7, v55, s51 bitop3:0xf6
    s_waitcnt vmcnt(1)
    v_bitop3_b32 v6, v6, v56, s48 bitop3:0xf6
    v_bitop3_b32 v7, v7, v57, s49 bitop3:0xf6
    v_bitop3_b32 v6, v6, v58, s50 bitop3:0xf6
    v_bitop3_b32 v7, v7, v59, s51 bitop3:0xf6
    s_waitcnt vmcnt(0)
    v_bitop3_b32 v6, v6, v60, s48 bitop3:0xf6
    v_bitop3_b32 v7, v7, v61, s49 bitop3:0xf6
    v_bitop3_b32 v6, v6, v62, s50 bitop3:0xf6
    v_bitop3_b32 v7, v7, v63, s51 bitop3:0xf6
    v_bitop3_b32 v6, v6, v7, v2 bitop3:0x54
    v_cmp_ne_u32 vcc, 0, v6
    s_nop 0
    s_and_b64 exec, exec, vcc
    s_cbranch_scc1 L_pollr8
    s_mov_b64 exec, -1
    v_pk_add_f32 v[32:33], v[32:33], v[40:41]
    v_pk_add_f32 v[34:35], v[34:35], v[42:43]
    v_pk_add_f32 v[36:37], v[36:37], v[44:45]
    v_pk_add_f32 v[38:39], v[38:39], v[46:47]
    v_pk_add_f32 v[48:49], v[48:49], v[56:57]
    v_pk_add_f32 v[50:51], v[50:51], v[58:59]
    v_pk_add_f32 v[52:53], v[52:53], v[60:61]
    v_pk_add_f32 v[54:55], v[54:55], v[62:63]
    v_pk_add_f32 v[32:33], v[32:33], v[48:49]
    v_pk_add_f32 v[34:35], v[34:35], v[50:51]
    v_pk_add_f32 v[36:37], v[36:37], v[52:53]
    v_pk_add_f32 v[38:39], v[38:39], v[54:55]
    v_cvt_pk_bf16_f32 v40, v32, v33
    v_cvt_pk_bf16_f32 v41, v34, v35
    v_cvt_pk_bf16_f32 v42, v36, v37
    v_cvt_pk_bf16_f32 v43, v38, v39
    v_lshlrev_b32 v5, 4, v0
    ds_write_b128 v5, v[40:43] offset:3328
    v_mov_b32 v16, s78
    ds_write_b32 v1, v16 offset:0
    v_and_b32 v5, 31, v0
    v_lshlrev_b32 v6, 3, v5
    s_lshl_b32 s72, s77, 9
    s_add_u32 s72, s72, 16384
    v_lshl_add_u32 v8, v5, 4, s72
    s_lshl_b32 s73, s31, 4
    s_add_u32 s73, s73, s72
    v_lshrrev_b32 v9, 3, v5
    v_lshl_add_u32 v12, v9, 7, s73
    v_and_b32 v5, 7, v0
    v_lshlrev_b32 v5, 4, v5
    v_lshl_add_u32 v5, v9, 2, v5
    s_mov_b32 s64, 0x3fb8aa3b
    s_branch L_lw9
L_lwr9:
    s_sleep 1
L_lw9:
    ds_read_b32 v19, v1 offset:4
    s_add_u32 s53, s53, 1
    s_cmp_gt_u32 s53, 4194304
    s_cbranch_scc1 L_end
    s_waitcnt lgkmcnt(0)
    v_cmp_ne_u32 vcc, 8, v19
    s_cbranch_vccnz L_lwr9
    ds_read_b64 v[16:17], v6 offset:2816
    s_waitcnt lgkmcnt(0)
    v_mov_b32 v20, v16
    s_nop 1
    v_max_f32_dpp v20, v20, v20 quad_perm:[1,0,3,2] row_mask:0xf bank_mask:0xf
    s_nop 1
    v_max_f32_dpp v20, v20, v20 quad_perm:[2,3,0,1] row_mask:0xf bank_mask:0xf
    s_nop 1
    v_max_f32_dpp v20, v20, v20 row_half_mirror row_mask:0xf bank_mask:0xf
    v_sub_f32 v21, v16, v20
    v_mul_f32 v21, s64, v21
    v_exp_f32 v21, v21
    s_nop 0
    v_mul_f32 v21, v21, v17
    v_or_b32 v20, s48, v20
    s_nop 0
    v_add_f32_dpp v21, v21, v21 quad_perm:[1,0,3,2] row_mask:0xf bank_mask:0xf
    s_nop 1
    v_add_f32_dpp v21, v21, v21 quad_perm:[2,3,0,1] row_mask:0xf bank_mask:0xf
    s_nop 1
    v_add_f32_dpp v21, v21, v21 row_half_mirror row_mask:0xf bank_mask:0xf
    v_and_or_b32 v21, v21, v2, s49
    v_mov_b32 v22, s50
    v_mov_b32 v23, s51
    s_mov_b32 exec_lo, 0x01010101
    s_mov_b32 exec_hi, 0
    s_cmp_eq_u32 s78, 1
    s_cbranch_scc0 L_ps10
    global_store_dwordx4 v12, v[20:23], s[26:27] offset:0
L_pd10:
    s_mov_b32 exec_lo, -1
    s_sleep 8
    s_branch L_poll11
L_pollr11:
    s_sleep 4
L_poll11:
    global_load_dwordx4 v[24:27], v8, s[26:27] offset:0 sc1
    s_add_u32 s53, s53, 1
    s_cmp_gt_u32 s53, 4194304
    s_cbranch_scc1 L_end
    s_waitcnt vmcnt(0)
    v_xor_b32 v6, s48, v24
    v_xor_b32 v7, s49, v25
    v_bitop3_b32 v6, v6, v26, s50 bitop3:0xf6
    v_bitop3_b32 v7, v7, v27, s51 bitop3:0xf6
    v_bitop3_b32 v6, v6, v7, v2 bitop3:0x54
    v_cmp_ne_u32 vcc, 0, v6
    s_nop 0
    s_and_b64 exec, exec, vcc
    s_cbranch_scc1 L_pollr11
    s_mov_b64 exec, -1
    v_and_b32 v24, v2, v24
    v_mov_b32 v20, v24
    s_nop 1
    v_max_f32_dpp v20, v20, v20 quad_perm:[1,0,3,2] row_mask:0xf bank_mask:0xf
    s_nop 1
    v_max_f32_dpp v20, v20, v20 quad_perm:[2,3,0,1] row_mask:0xf bank_mask:0xf
    s_nop 1
    v_max_f32_dpp v20, v20, v20 row_half_mirror row_mask:0xf bank_mask:0xf
    v_sub_f32 v21, v24, v20
    v_mul_f32 v21, s64, v21
    v_exp_f32 v21, v21
    s_nop 0
    v_mul_f32 v21, v21, v25
    s_nop 1
    v_add_f32_dpp v21, v21, v21 quad_perm:[1,0,3,2] row_mask:0xf bank_mask:0xf
    s_nop 1
    v_add_f32_dpp v21, v21, v21 quad_perm:[2,3,0,1] row_mask:0xf bank_mask:0xf
    s_nop 1
    v_add_f32_dpp v21, v21, v21 row_half_mirror row_mask:0xf bank_mask:0xf
    v_sub_f32 v22, v16, v20
    v_mul_f32 v22, s64, v22
    v_exp_f32 v22, v22
    v_rcp_f32 v21, v21
    s_nop 0
    v_mul_f32 v22, v22, v21
    s_mov_b32 exec_hi, 0
    ds_write_b32 v5, v22 offset:3072
    v_mov_b32 v7, 1
    s_mov_b64 exec, 1
    ds_add_u32 v1, v7 offset:12
    s_mov_b64 exec, -1
    s_branch L_tail
L_hf:
    s_mov_b32 s63, 0x07060302
    s_lshl_b32 s64, s28, 3
    s_add_u32 s64, s64, s29
    s_cmp_lt_u32 s29, 8
    s_cbranch_scc0 L_nz
    v_mov_b32 v24, 0
    v_mov_b32 v25, 0
    v_mov_b32 v26, 0
    v_mov_b32 v27, 0
    s_lshl_b32 s72, s64, 9
    s_add_u32 s72, s72, 65536
    v_lshl_add_u32 v6, v0, 4, s72
    s_mov_b32 exec_hi, 0
    global_store_dwordx4 v6, v[24:27], s[26:27] sc1
    s_mov_b64 exec, -1
L_nz:
    s_cmp_lt_u32 s54, 28
    s_cbranch_scc0 L_hg
    s_and_b32 s72, s55, 1
    s_lshl_b32 s72, s72, 7
    v_add_u32 v5, s72, v5
    ds_read_b128 v[32:35], v5 offset:1280
    ds_read_b128 v[36:39], v5 offset:1344
    s_lshl_b32 s72, s28, 16
    s_and_b32 s73, s29, 3
    s_lshl_b32 s73, s73, 11
    s_add_u32 s72, s72, s73
    s_lshl_b32 s73, s55, 8
    s_add_u32 s72, s72, s73
    s_add_u32 s72, s72, 524288
    v_lshrrev_b32 v20, 1, v3
    v_lshlrev_b32 v20, 13, v20
    v_lshl_add_u32 v20, v11, 5, v20
    v_and_b32 v7, 1, v3
    v_lshl_add_u32 v20, v7, 4, v20
    v_add_u32 v20, s72, v20
    v_add_u32 v21, 16384, v20
    v_add_u32 v22, 32768, v20
    v_add_u32 v23, 49152, v20
    s_branch L_lw12
L_lwr12:
    s_sleep 1
L_lw12:
    ds_read_b32 v12, v1 offset:36
    s_add_u32 s53, s53, 1
    s_cmp_gt_u32 s53, 4194304
    s_cbranch_scc1 L_end
    s_waitcnt lgkmcnt(0)
    v_cmp_ne_u32 vcc, 8, v12
    s_cbranch_vccnz L_lwr12
    ds_read_b64_tr_b16 v[96:97], v15 offset:24576
    ds_read_b64_tr_b16 v[98:99], v15 offset:25088
    ds_read_b64_tr_b16 v[100:101], v15 offset:28672
    ds_read_b64_tr_b16 v[102:103], v15 offset:29184
    ds_read_b64_tr_b16 v[104:105], v15 offset:24608
    ds_read_b64_tr_b16 v[106:107], v15 offset:25120
    ds_read_b64_tr_b16 v[108:109], v15 offset:28704
    ds_read_b64_tr_b16 v[110:111], v15 offset:29216
    ds_read_b64_tr_b16 v[112:113], v15 offset:24640
    ds_read_b64_tr_b16 v[114:115], v15 offset:25152
    ds_read_b64_tr_b16 v[116:117], v15 offset:28736
    ds_read_b64_tr_b16 v[118:119], v15 offset:29248
    ds_read_b64_tr_b16 v[120:121], v15 offset:24672
    ds_read_b64_tr_b16 v[122:123], v15 offset:25184
    ds_read_b64_tr_b16 v[124:125], v15 offset:28768
    ds_read_b64_tr_b16 v[126:127], v15 offset:29280
    ds_read_b64_tr_b16 v[128:129], v15 offset:32768
    ds_read_b64_tr_b16 v[130:131], v15 offset:33280
    ds_read_b64_tr_b16 v[132:133], v15 offset:36864
    ds_read_b64_tr_b16 v[134:135], v15 offset:37376
    ds_read_b64_tr_b16 v[136:137], v15 offset:32800
    ds_read_b64_tr_b16 v[138:139], v15 offset:33312
    ds_read_b64_tr_b16 v[140:141], v15 offset:36896
    ds_read_b64_tr_b16 v[142:143], v15 offset:37408
    ds_read_b64_tr_b16 v[144:145], v15 offset:32832
    ds_read_b64_tr_b16 v[146:147], v15 offset:33344
    ds_read_b64_tr_b16 v[148:149], v15 offset:36928
    ds_read_b64_tr_b16 v[150:151], v15 offset:37440
    ds_read_b64_tr_b16 v[152:153], v15 offset:32864
    ds_read_b64_tr_b16 v[154:155], v15 offset:33376
    ds_read_b64_tr_b16 v[156:157], v15 offset:36960
    ds_read_b64_tr_b16 v[158:159], v15 offset:37472
    s_waitcnt lgkmcnt(0)
    v_mfma_f32_16x16x32_bf16 v[64:67], v[96:99], v[32:35], 0
    v_mfma_f32_16x16x32_bf16 v[68:71], v[104:107], v[32:35], 0
    v_mfma_f32_16x16x32_bf16 v[72:75], v[112:115], v[32:35], 0
    v_mfma_f32_16x16x32_bf16 v[76:79], v[120:123], v[32:35], 0
    v_mfma_f32_16x16x32_bf16 v[64:67], v[100:103], v[36:39], v[64:67]
    v_mfma_f32_16x16x32_bf16 v[68:71], v[108:111], v[36:39], v[68:71]
    v_mfma_f32_16x16x32_bf16 v[72:75], v[116:119], v[36:39], v[72:75]
    v_mfma_f32_16x16x32_bf16 v[76:79], v[124:127], v[36:39], v[76:79]
    v_mfma_f32_16x16x32_bf16 v[80:83], v[128:131], v[32:35], 0
    v_mfma_f32_16x16x32_bf16 v[84:87], v[136:139], v[32:35], 0
    v_mfma_f32_16x16x32_bf16 v[88:91], v[144:147], v[32:35], 0
    v_mfma_f32_16x16x32_bf16 v[92:95], v[152:155], v[32:35], 0
    v_mfma_f32_16x16x32_bf16 v[80:83], v[132:135], v[36:39], v[80:83]
    v_mfma_f32_16x16x32_bf16 v[84:87], v[140:143], v[36:39], v[84:87]
    v_mfma_f32_16x16x32_bf16 v[88:91], v[148:151], v[36:39], v[88:91]
    v_mfma_f32_16x16x32_bf16 v[92:95], v[156:159], v[36:39], v[92:95]
    s_branch L_lw13
L_lwr13:
    s_sleep 1
L_lw13:
    ds_read_b32 v12, v1 offset:8
    s_add_u32 s53, s53, 1
    s_cmp_gt_u32 s53, 4194304
    s_cbranch_scc1 L_end
    s_waitcnt lgkmcnt(0)
    v_cmp_eq_u32 vcc, 0, v12
    s_cbranch_vccnz L_lwr13
    v_readfirstlane_b32 s78, v12
    v_and_or_b32 v64, v64, v2, s48
    v_and_or_b32 v65, v65, v2, s49
    v_and_or_b32 v66, v66, v2, s50
    v_and_or_b32 v67, v67, v2, s51
    v_and_or_b32 v68, v68, v2, s48
    v_and_or_b32 v69, v69, v2, s49
    v_and_or_b32 v70, v70, v2, s50
    v_and_or_b32 v71, v71, v2, s51
    v_and_or_b32 v72, v72, v2, s48
    v_and_or_b32 v73, v73, v2, s49
    v_and_or_b32 v74, v74, v2, s50
    v_and_or_b32 v75, v75, v2, s51
    v_and_or_b32 v76, v76, v2, s48
    v_and_or_b32 v77, v77, v2, s49
    v_and_or_b32 v78, v78, v2, s50
    v_and_or_b32 v79, v79, v2, s51
    v_and_or_b32 v80, v80, v2, s48
    v_and_or_b32 v81, v81, v2, s49
    v_and_or_b32 v82, v82, v2, s50
    v_and_or_b32 v83, v83, v2, s51
    v_and_or_b32 v84, v84, v2, s48
    v_and_or_b32 v85, v85, v2, s49
    v_and_or_b32 v86, v86, v2, s50
    v_and_or_b32 v87, v87, v2, s51
    v_and_or_b32 v88, v88, v2, s48
    v_and_or_b32 v89, v89, v2, s49
    v_and_or_b32 v90, v90, v2, s50
    v_and_or_b32 v91, v91, v2, s51
    v_and_or_b32 v92, v92, v2, s48
    v_and_or_b32 v93, v93, v2, s49
    v_and_or_b32 v94, v94, v2, s50
    v_and_or_b32 v95, v95, v2, s51
    s_mov_b32 exec_lo, 0x000f000f
    s_mov_b32 exec_hi, 0x000f000f
    s_cmp_eq_u32 s78, 1
    s_cbranch_scc0 L_ps14
    global_store_dwordx4 v20, v[64:67], s[26:27] offset:0
    global_store_dwordx4 v21, v[68:71], s[26:27] offset:0
    global_store_dwordx4 v22, v[72:75], s[26:27] offset:0
    global_store_dwordx4 v23, v[76:79], s[26:27] offset:0
    global_store_dwordx4 v20, v[80:83], s[26:27] offset:128
    global_store_dwordx4 v21, v[84:87], s[26:27] offset:128
    global_store_dwordx4 v22, v[88:91], s[26:27] offset:128
    global_store_dwordx4 v23, v[92:95], s[26:27] offset:128
L_pd14:
    s_mov_b64 exec, -1
    s_lshl_b32 s72, s54, 3
    s_add_u32 s65, s72, s55
    s_lshl_b32 s72, s28, 5
    s_add_u32 s72, s72, s29
    s_lshl_b32 s72, s72, 11
    s_add_u32 s72, s72, 524288
    v_lshlrev_b32 v5, 8, v9
    v_and_b32 v8, 7, v0
    v_lshl_add_u32 v5, v8, 4, v5
    v_add_u32 v5, s72, v5
    s_lshl_b32 s72, s65, 7
    s_add_u32 s72, s72, 32768
    v_lshl_add_u32 v8, v0, 4, s72
    s_sleep 16
    s_branch L_poll15
L_pollr15:
    s_sleep 4
L_poll15:
    global_load_dwordx4 v[20:23], v5, s[26:27] offset:0 sc1
    global_load_dwordx4 v[24:27], v5, s[26:27] offset:128 sc1
    s_add_u32 s53, s53, 1
    s_cmp_gt_u32 s53, 4194304
    s_cbranch_scc1 L_end
    s_waitcnt vmcnt(1)
    v_xor_b32 v6, s48, v20
    v_xor_b32 v7, s49, v21
    v_bitop3_b32 v6, v6, v22, s50 bitop3:0xf6
    v_bitop3_b32 v7, v7, v23, s51 bitop3:0xf6
    s_waitcnt vmcnt(0)
    v_bitop3_b32 v6, v6, v24, s48 bitop3:0xf6
    v_bitop3_b32 v7, v7, v25, s49 bitop3:0xf6
    v_bitop3_b32 v6, v6, v26, s50 bitop3:0xf6
    v_bitop3_b32 v7, v7, v27, s51 bitop3:0xf6
    v_bitop3_b32 v6, v6, v7, v2 bitop3:0x54
    v_cmp_ne_u32 vcc, 0, v6
    s_nop 0
    s_and_b64 exec, exec, vcc
    s_cbranch_scc1 L_pollr15
    s_mov_b64 exec, -1
    v_permlane32_swap_b32 v20, v24
    v_permlane32_swap_b32 v21, v25
    v_permlane32_swap_b32 v22, v26
    v_permlane32_swap_b32 v23, v27
    v_add_f32 v20, v20, v24
    v_add_f32 v21, v21, v25
    v_add_f32 v22, v22, v26
    v_add_f32 v23, v23, v27
    v_mov_b32 v24, v20
    v_mov_b32 v25, v21
    v_mov_b32 v26, v22
    v_mov_b32 v27, v23
    v_permlane16_swap_b32 v20, v24
    v_permlane16_swap_b32 v21, v25
    v_permlane16_swap_b32 v22, v26
    v_permlane16_swap_b32 v23, v27
    v_add_f32 v20, v20, v24
    v_add_f32 v21, v21, v25
    v_add_f32 v22, v22, v26
    v_add_f32 v23, v23, v27
    v_add_f32_dpp v20, v20, v20 row_ror:8 row_mask:0xf bank_mask:0xf
    v_add_f32_dpp v21, v21, v21 row_ror:8 row_mask:0xf bank_mask:0xf
    v_add_f32_dpp v22, v22, v22 row_ror:8 row_mask:0xf bank_mask:0xf
    v_add_f32_dpp v23, v23, v23 row_ror:8 row_mask:0xf bank_mask:0xf
    v_cvt_pk_bf16_f32 v20, 0, v20
    v_cvt_pk_bf16_f32 v21, 0, v21
    v_cvt_pk_bf16_f32 v22, 0, v22
    v_cvt_pk_bf16_f32 v23, 0, v23
    v_permlane32_swap_b32 v20, v24
    v_permlane32_swap_b32 v21, v25
    v_permlane32_swap_b32 v22, v26
    v_permlane32_swap_b32 v23, v27
    v_mul_f32 v28, 0xbfb8aa3b, v20
    v_mul_f32 v29, 0xbfb8aa3b, v21
    v_mul_f32 v30, 0xbfb8aa3b, v22
    v_mul_f32 v31, 0xbfb8aa3b, v23
    v_exp_f32 v28, v28
    v_exp_f32 v29, v29
    v_exp_f32 v30, v30
    v_exp_f32 v31, v31
    v_add_f32 v28, 1.0, v28
    v_add_f32 v29, 1.0, v29
    v_add_f32 v30, 1.0, v30
    v_add_f32 v31, 1.0, v31
    v_rcp_f32 v28, v28
    v_rcp_f32 v29, v29
    v_rcp_f32 v30, v30
    v_rcp_f32 v31, v31
    v_mul_f32 v28, v28, v20
    v_mul_f32 v29, v29, v21
    v_mul_f32 v30, v30, v22
    v_mul_f32 v31, v31, v23
    v_cvt_pk_bf16_f32 v28, 0, v28
    v_cvt_pk_bf16_f32 v29, 0, v29
    v_cvt_pk_bf16_f32 v30, 0, v30
    v_cvt_pk_bf16_f32 v31, 0, v31
    v_mul_f32 v28, v28, v24
    v_mul_f32 v29, v29, v25
    v_mul_f32 v30, v30, v26
    v_mul_f32 v31, v31, v27
    v_cvt_pk_bf16_f32 v28, 0, v28
    v_cvt_pk_bf16_f32 v29, 0, v29
    v_cvt_pk_bf16_f32 v30, 0, v30
    v_cvt_pk_bf16_f32 v31, 0, v31
    v_or_b32 v28, s48, v28
    v_or_b32 v29, s49, v29
    v_or_b32 v30, s50, v30
    v_or_b32 v31, s51, v31
    s_mov_b64 exec, 0xff
    global_store_dwordx4 v8, v[28:31], s[26:27] sc1
    s_mov_b64 exec, -1
L_hg:
    v_mov_b32 v7, 1
    s_mov_b64 exec, 1
    ds_add_u32 v1, v7 offset:12
    s_mov_b64 exec, -1
    s_cmp_lt_u32 s29, 28
    s_cbranch_scc0 L_tail
    s_lshl_b32 s72, s29, 10
    s_add_u32 s72, s72, 32768
    v_lshlrev_b32 v5, 5, v11
    v_lshl_add_u32 v5, v3, 7, v5
    v_add_u32 v5, s72, v5
    s_branch L_lw16
L_lwr16:
    s_sleep 1
L_lw16:
    ds_read_b32 v12, v1 offset:8
    s_add_u32 s53, s53, 1
    s_cmp_gt_u32 s53, 4194304
    s_cbranch_scc1 L_end
    s_waitcnt lgkmcnt(0)
    v_cmp_eq_u32 vcc, 0, v12
    s_cbranch_vccnz L_lwr16
    v_readfirstlane_b32 s78, v12
    s_branch L_lw17
L_lwr17:
    s_sleep 8
L_lw17:
    ds_read_b32 v12, v1 offset:48
    s_add_u32 s53, s53, 1
    s_cmp_gt_u32 s53, 4194304
    s_cbranch_scc1 L_end
    s_waitcnt lgkmcnt(0)
    v_cmp_ne_u32 vcc, 8, v12
    s_cbranch_vccnz L_lwr17
    ds_read_b64_tr_b16 v[96:97], v15 offset:40960
    ds_read_b64_tr_b16 v[98:99], v15 offset:41472
    ds_read_b64_tr_b16 v[100:101], v15 offset:45056
    ds_read_b64_tr_b16 v[102:103], v15 offset:45568
    ds_read_b64_tr_b16 v[104:105], v15 offset:40992
    ds_read_b64_tr_b16 v[106:107], v15 offset:41504
    ds_read_b64_tr_b16 v[108:109], v15 offset:45088
    ds_read_b64_tr_b16 v[110:111], v15 offset:45600
    ds_read_b64_tr_b16 v[112:113], v15 offset:41024
    ds_read_b64_tr_b16 v[114:115], v15 offset:41536
    ds_read_b64_tr_b16 v[116:117], v15 offset:45120
    ds_read_b64_tr_b16 v[118:119], v15 offset:45632
    ds_read_b64_tr_b16 v[120:121], v15 offset:41056
    ds_read_b64_tr_b16 v[122:123], v15 offset:41568
    ds_read_b64_tr_b16 v[124:125], v15 offset:45152
    ds_read_b64_tr_b16 v[126:127], v15 offset:45664
    s_sleep 4
    s_mov_b32 exec_lo, 0x000f000f
    s_mov_b32 exec_hi, 0x000f000f
    s_branch L_poll18
L_pollr18:
    s_sleep 4
L_poll18:
    global_load_dwordx4 v[32:35], v5, s[26:27] offset:0 sc1
    global_load_dwordx4 v[36:39], v5, s[26:27] offset:16 sc1
    global_load_dwordx4 v[40:43], v5, s[26:27] offset:512 sc1
    global_load_dwordx4 v[44:47], v5, s[26:27] offset:528 sc1
    s_add_u32 s53, s53, 1
    s_cmp_gt_u32 s53, 4194304
    s_cbranch_scc1 L_end
    s_waitcnt vmcnt(3)
    v_xor_b32 v6, s48, v32
    v_xor_b32 v7, s49, v33
    v_bitop3_b32 v6, v6, v34, s50 bitop3:0xf6
    v_bitop3_b32 v7, v7, v35, s51 bitop3:0xf6
    s_waitcnt vmcnt(2)
    v_bitop3_b32 v6, v6, v36, s48 bitop3:0xf6
    v_bitop3_b32 v7, v7, v37, s49 bitop3:0xf6
    v_bitop3_b32 v6, v6, v38, s50 bitop3:0xf6
    v_bitop3_b32 v7, v7, v39, s51 bitop3:0xf6
    s_waitcnt vmcnt(1)
    v_bitop3_b32 v6, v6, v40, s48 bitop3:0xf6
    v_bitop3_b32 v7, v7, v41, s49 bitop3:0xf6
    v_bitop3_b32 v6, v6, v42, s50 bitop3:0xf6
    v_bitop3_b32 v7, v7, v43, s51 bitop3:0xf6
    s_waitcnt vmcnt(0)
    v_bitop3_b32 v6, v6, v44, s48 bitop3:0xf6
    v_bitop3_b32 v7, v7, v45, s49 bitop3:0xf6
    v_bitop3_b32 v6, v6, v46, s50 bitop3:0xf6
    v_bitop3_b32 v7, v7, v47, s51 bitop3:0xf6
    v_bitop3_b32 v6, v6, v7, v2 bitop3:0x54
    v_cmp_ne_u32 vcc, 0, v6
    s_nop 0
    s_and_b64 exec, exec, vcc
    s_cbranch_scc1 L_pollr18
    s_mov_b64 exec, -1
    v_perm_b32 v48, v33, v32, s63
    v_perm_b32 v49, v35, v34, s63
    v_perm_b32 v50, v37, v36, s63
    v_perm_b32 v51, v39, v38, s63
    v_perm_b32 v52, v41, v40, s63
    v_perm_b32 v53, v43, v42, s63
    v_perm_b32 v54, v45, v44, s63
    v_perm_b32 v55, v47, v46, s63
    s_waitcnt lgkmcnt(0)
    v_mfma_f32_16x16x32_bf16 v[64:67], v[96:99], v[48:51], 0
    v_mfma_f32_16x16x32_bf16 v[68:71], v[104:107], v[48:51], 0
    v_mfma_f32_16x16x32_bf16 v[72:75], v[112:115], v[48:51], 0
    v_mfma_f32_16x16x32_bf16 v[76:79], v[120:123], v[48:51], 0
    v_mfma_f32_16x16x32_bf16 v[64:67], v[100:103], v[52:55], v[64:67]
    v_mfma_f32_16x16x32_bf16 v[68:71], v[108:111], v[52:55], v[68:71]
    v_mfma_f32_16x16x32_bf16 v[72:75], v[116:119], v[52:55], v[72:75]
    v_mfma_f32_16x16x32_bf16 v[76:79], v[124:127], v[52:55], v[76:79]
    s_lshl_b32 s72, s28, 15
    s_lshl_b32 s73, s29, 10
    s_add_u32 s72, s72, s73
    s_add_u32 s72, s72, 1310720
    v_lshlrev_b32 v5, 5, v11
    v_lshrrev_b32 v6, 1, v3
    v_lshl_add_u32 v5, v6, 7, v5
    v_and_b32 v6, 1, v3
    v_lshl_add_u32 v5, v6, 4, v5
    v_add_u32 v5, s72, v5
    v_and_or_b32 v64, v64, v2, s48
    v_and_or_b32 v65, v65, v2, s49
    v_and_or_b32 v66, v66, v2, s50
    v_and_or_b32 v67, v67, v2, s51
    v_and_or_b32 v68, v68, v2, s48
    v_and_or_b32 v69, v69, v2, s49
    v_and_or_b32 v70, v70, v2, s50
    v_and_or_b32 v71, v71, v2, s51
    v_and_or_b32 v72, v72, v2, s48
    v_and_or_b32 v73, v73, v2, s49
    v_and_or_b32 v74, v74, v2, s50
    v_and_or_b32 v75, v75, v2, s51
    v_and_or_b32 v76, v76, v2, s48
    v_and_or_b32 v77, v77, v2, s49
    v_and_or_b32 v78, v78, v2, s50
    v_and_or_b32 v79, v79, v2, s51
    s_mov_b32 exec_lo, 0x000f000f
    s_mov_b32 exec_hi, 0x000f000f
    s_cmp_eq_u32 s78, 1
    s_cbranch_scc0 L_ps19
    global_store_dwordx4 v5, v[64:67], s[26:27] offset:0
    global_store_dwordx4 v5, v[68:71], s[26:27] offset:256
    global_store_dwordx4 v5, v[72:75], s[26:27] offset:512
    global_store_dwordx4 v5, v[76:79], s[26:27] offset:768
L_pd19:
    s_mov_b64 exec, -1
    s_cmp_lt_u32 s29, 8
    s_cbranch_scc0 L_tail
    v_mov_b32 v60, s48
    v_mov_b32 v61, s49
    v_mov_b32 v62, s50
    v_mov_b32 v63, s51
    s_lshl_b32 s72, s28, 15
    s_lshl_b32 s73, s29, 7
    s_add_u32 s72, s72, s73
    s_add_u32 s72, s72, 1310720
    v_lshlrev_b32 v20, 10, v9
    v_and_b32 v7, 7, v0
    v_lshl_add_u32 v20, v7, 4, v20
    v_add_u32 v20, s72, v20
    v_add_u32 v21, 8192, v20
    v_add_u32 v22, 16384, v20
    v_add_u32 v23, 24576, v20
    s_lshl_b32 s72, s64, 7
    s_add_u32 s72, s72, 4096
    v_lshl_add_u32 v8, v0, 4, s72
    s_sleep 20
    s_branch L_poll20
L_pollr20:
    s_sleep 4
L_poll20:
    s_mov_b32 s72, exec_hi
    s_and_b32 exec_hi, exec_hi, 0x0
    global_load_dwordx4 v[60:63], v23, s[26:27] offset:0 sc1
    s_mov_b32 exec_hi, s72
    global_load_dwordx4 v[48:51], v20, s[26:27] offset:0 sc1
    global_load_dwordx4 v[52:55], v21, s[26:27] offset:0 sc1
    global_load_dwordx4 v[56:59], v22, s[26:27] offset:0 sc1
    s_add_u32 s53, s53, 1
    s_cmp_gt_u32 s53, 4194304
    s_cbranch_scc1 L_end
    s_waitcnt vmcnt(3)
    v_xor_b32 v6, s48, v60
    v_xor_b32 v7, s49, v61
    v_bitop3_b32 v6, v6, v62, s50 bitop3:0xf6
    v_bitop3_b32 v7, v7, v63, s51 bitop3:0xf6
    s_waitcnt vmcnt(2)
    v_bitop3_b32 v6, v6, v48, s48 bitop3:0xf6
    v_bitop3_b32 v7, v7, v49, s49 bitop3:0xf6
    v_bitop3_b32 v6, v6, v50, s50 bitop3:0xf6
    v_bitop3_b32 v7, v7, v51, s51 bitop3:0xf6
    s_waitcnt vmcnt(1)
    v_bitop3_b32 v6, v6, v52, s48 bitop3:0xf6
    v_bitop3_b32 v7, v7, v53, s49 bitop3:0xf6
    v_bitop3_b32 v6, v6, v54, s50 bitop3:0xf6
    v_bitop3_b32 v7, v7, v55, s51 bitop3:0xf6
    s_waitcnt vmcnt(0)
    v_bitop3_b32 v6, v6, v56, s48 bitop3:0xf6
    v_bitop3_b32 v7, v7, v57, s49 bitop3:0xf6
    v_bitop3_b32 v6, v6, v58, s50 bitop3:0xf6
    v_bitop3_b32 v7, v7, v59, s51 bitop3:0xf6
    v_bitop3_b32 v6, v6, v7, v2 bitop3:0x54
    v_cmp_ne_u32 vcc, 0, v6
    s_nop 0
    s_and_b64 exec, exec, vcc
    s_cbranch_scc1 L_pollr20
    s_mov_b64 exec, -1
    v_pk_add_f32 v[48:49], v[48:49], v[52:53]
    v_pk_add_f32 v[50:51], v[50:51], v[54:55]
    v_pk_add_f32 v[56:57], v[56:57], v[60:61]
    v_pk_add_f32 v[58:59], v[58:59], v[62:63]
    v_pk_add_f32 v[48:49], v[48:49], v[56:57]
    v_pk_add_f32 v[50:51], v[50:51], v[58:59]
    v_mov_b32 v52, v48
    v_mov_b32 v53, v49
    v_mov_b32 v54, v50
    v_mov_b32 v55, v51
    v_permlane32_swap_b32 v48, v52
    v_permlane32_swap_b32 v49, v53
    v_permlane32_swap_b32 v50, v54
    v_permlane32_swap_b32 v51, v55
    v_add_f32 v48, v48, v52
    v_add_f32 v49, v49, v53
    v_add_f32 v50, v50, v54
    v_add_f32 v51, v51, v55
    v_mov_b32 v52, v48
    v_mov_b32 v53, v49
    v_mov_b32 v54, v50
    v_mov_b32 v55, v51
    v_permlane16_swap_b32 v48, v52
    v_permlane16_swap_b32 v49, v53
    v_permlane16_swap_b32 v50, v54
    v_permlane16_swap_b32 v51, v55
    v_add_f32 v48, v48, v52
    v_add_f32 v49, v49, v53
    v_add_f32 v50, v50, v54
    v_add_f32 v51, v51, v55
    v_add_f32_dpp v48, v48, v48 row_ror:8 row_mask:0xf bank_mask:0xf
    v_add_f32_dpp v49, v49, v49 row_ror:8 row_mask:0xf bank_mask:0xf
    v_add_f32_dpp v50, v50, v50 row_ror:8 row_mask:0xf bank_mask:0xf
    v_add_f32_dpp v51, v51, v51 row_ror:8 row_mask:0xf bank_mask:0xf
    v_cvt_pk_bf16_f32 v48, 0, v48
    v_cvt_pk_bf16_f32 v49, 0, v49
    v_cvt_pk_bf16_f32 v50, 0, v50
    v_cvt_pk_bf16_f32 v51, 0, v51
    v_mul_f32 v52, 0xbfb8aa3b, v48
    v_mul_f32 v53, 0xbfb8aa3b, v49
    v_mul_f32 v54, 0xbfb8aa3b, v50
    v_mul_f32 v55, 0xbfb8aa3b, v51
    v_exp_f32 v52, v52
    v_exp_f32 v53, v53
    v_exp_f32 v54, v54
    v_exp_f32 v55, v55
    v_add_f32 v52, 1.0, v52
    v_add_f32 v53, 1.0, v53
    v_add_f32 v54, 1.0, v54
    v_add_f32 v55, 1.0, v55
    v_rcp_f32 v52, v52
    v_rcp_f32 v53, v53
    v_rcp_f32 v54, v54
    v_rcp_f32 v55, v55
    v_mul_f32 v52, v52, v48
    v_mul_f32 v53, v53, v49
    v_mul_f32 v54, v54, v50
    v_mul_f32 v55, v55, v51
    v_cvt_pk_bf16_f32 v52, 0, v52
    v_cvt_pk_bf16_f32 v53, 0, v53
    v_cvt_pk_bf16_f32 v54, 0, v54
    v_cvt_pk_bf16_f32 v55, 0, v55
    v_or_b32 v52, s48, v52
    v_or_b32 v53, s49, v53
    v_or_b32 v54, s50, v54
    v_or_b32 v55, s51, v55
    s_mov_b64 exec, 0xff
    global_store_dwordx4 v8, v[52:55], s[26:27] sc1
    s_mov_b64 exec, -1
L_tail:
    s_lshl_b32 s72, s28, 2
    s_add_u32 s72, s72, s3
    s_lshl_b32 s72, s72, 14
    s_lshl_b32 s73, s30, 9
    s_add_u32 s72, s72, s73
    s_add_u32 s72, s72, 528384
    v_lshrrev_b32 v7, 5, v0
    v_and_b32 v6, 31, v0
    v_lshlrev_b32 v28, 13, v7
    v_lshl_add_u32 v28, v6, 4, v28
    v_add_u32 v28, s72, v28
    s_mul_i32 s72, s3, 320
    v_lshlrev_b32 v29, 3, v6
    v_lshl_add_u32 v29, v7, 2, v29
    v_add_u32 v29, s72, v29
    v_mul_u32_u24 v30, 320, v11
    v_lshl_add_u32 v30, v3, 4, v30
    v_and_b32 v7, 1, v3
    v_bfe_u32 v31, v0, 3, 1
    v_lshl_or_b32 v31, v7, 1, v31
    v_xor_b32 v31, s3, v31
    v_lshl_add_u32 v31, v31, 5, v15
    s_lshl_b32 s72, s31, 2
    s_add_u32 s74, s72, s3
    s_lshl_b32 s72, s74, 8
    s_add_u32 s72, s72, 4096
    v_lshlrev_b32 v27, 5, v11
    v_lshl_add_u32 v27, v7, 4, v27
    v_lshrrev_b32 v7, 1, v3
    v_lshl_add_u32 v27, v7, 7, v27
    v_add_u32 v27, s72, v27
    s_lshl_b32 s72, s74, 5
    v_lshlrev_b32 v26, 10, v11
    v_lshl_add_u32 v26, v3, 3, v26
    v_add_u32 v26, s72, v26
    v_mov_b32 v25, 1
    v_cmp_eq_u32 s[60:61], 1, v10
    v_cmp_lt_u32 s[56:57], 1, v10
    s_lshl_b32 s72, s74, 10
    s_add_u32 s72, s72, 65536
    v_lshlrev_b32 v24, 8, v3
    v_lshl_add_u32 v24, v4, 2, v24
    v_add_u32 v24, s72, v24
    s_mov_b32 s58, 0x00ff00ff
    s_mov_b32 s59, 0x00ff00ff
    s_mov_b32 s62, 0x41f80000
    s_mov_b64 s[68:69], s[48:49]
    s_mov_b64 s[70:71], s[50:51]
    s_add_u32 s52, s52, 1
    s_and_b32 s48, s52, 0xff
    s_xor_b32 s49, s48, 0x55
    s_xor_b32 s50, s48, 0xaa
    s_xor_b32 s51, s48, 0xff
    s_branch L_lw21
L_lwr21:
    s_sleep 2
L_lw21:
    ds_read_b32 v12, v1 offset:20
    s_add_u32 s53, s53, 1
    s_cmp_gt_u32 s53, 4194304
    s_cbranch_scc1 L_end
    s_waitcnt lgkmcnt(0)
    v_cmp_eq_u32 vcc, 0, v12
    s_cbranch_vccnz L_lwr21
    global_load_dwordx2 v[20:21], v26, s[4:5]
    global_load_dwordx4 v[16:19], v27, s[26:27] sc1
L_lwr22:
    ds_read_b32 v12, v1 offset:44
    s_add_u32 s53, s53, 1
    s_cmp_gt_u32 s53, 4194304
    s_cbranch_scc1 L_end
    s_waitcnt lgkmcnt(0)
    v_cmp_ne_u32 vcc, 8, v12
    s_cbranch_vccnz L_lwr22
L_pollr23:
    global_load_dwordx4 v[32:35], v28, s[26:27] offset:-4096 sc1
    global_load_dwordx4 v[36:39], v28, s[26:27] offset:-2048 sc1
    global_load_dwordx4 v[40:43], v28, s[26:27] offset:0 sc1
    global_load_dwordx4 v[44:47], v28, s[26:27] offset:2048 sc1
    s_add_u32 s53, s53, 1
    s_cmp_gt_u32 s53, 4194304
    s_cbranch_scc1 L_end
    s_waitcnt vmcnt(3)
    v_xor_b32 v6, s48, v32
    v_xor_b32 v7, s49, v33
    v_bitop3_b32 v6, v6, v34, s50 bitop3:0xf6
    v_bitop3_b32 v7, v7, v35, s51 bitop3:0xf6
    s_waitcnt vmcnt(2)
    v_bitop3_b32 v6, v6, v36, s48 bitop3:0xf6
    v_bitop3_b32 v7, v7, v37, s49 bitop3:0xf6
    v_bitop3_b32 v6, v6, v38, s50 bitop3:0xf6
    v_bitop3_b32 v7, v7, v39, s51 bitop3:0xf6
    s_waitcnt vmcnt(1)
    v_bitop3_b32 v6, v6, v40, s48 bitop3:0xf6
    v_bitop3_b32 v7, v7, v41, s49 bitop3:0xf6
    v_bitop3_b32 v6, v6, v42, s50 bitop3:0xf6
    v_bitop3_b32 v7, v7, v43, s51 bitop3:0xf6
    s_waitcnt vmcnt(0)
    v_bitop3_b32 v6, v6, v44, s48 bitop3:0xf6
    v_bitop3_b32 v7, v7, v45, s49 bitop3:0xf6
    v_bitop3_b32 v6, v6, v46, s50 bitop3:0xf6
    v_bitop3_b32 v7, v7, v47, s51 bitop3:0xf6
    v_bitop3_b32 v6, v6, v7, v2 bitop3:0x54
    v_cmp_ne_u32 vcc, 0, v6
    s_nop 0
    s_and_b64 exec, exec, vcc
    s_cbranch_scc1 L_pollr23
    s_mov_b64 exec, -1
    v_pk_add_f32 v[32:33], v[32:33], v[36:37]
    v_pk_add_f32 v[34:35], v[34:35], v[38:39]
    v_pk_add_f32 v[40:41], v[40:41], v[44:45]
    v_pk_add_f32 v[42:43], v[42:43], v[46:47]
    v_pk_add_f32 v[32:33], v[32:33], v[40:41]
    v_pk_add_f32 v[34:35], v[34:35], v[42:43]
    s_nop 1
    v_permlane32_swap_b32 v32, v34
    v_permlane32_swap_b32 v33, v35
    v_pk_add_f32 v[32:33], v[32:33], v[34:35]
    v_cvt_pk_bf16_f32 v32, v32, v33
    ds_write_b32 v29, v32 offset:4352
    s_mov_b64 exec, 1
    ds_add_u32 v1, v25 offset:28
    s_mov_b64 exec, -1
L_obr:
    ds_read_b64 v[6:7], v1 offset:24
    ds_read_b128 v[48:51], v30 offset:4352
    ds_read_b64_tr_b16 v[64:65], v31 offset:49152
    ds_read_b64_tr_b16 v[66:67], v31 offset:49664
    ds_read_b128 v[52:55], v30 offset:4416
    ds_read_b64_tr_b16 v[68:69], v31 offset:53248
    ds_read_b64_tr_b16 v[70:71], v31 offset:53760
    ds_read_b128 v[56:59], v30 offset:4480
    ds_read_b64_tr_b16 v[72:73], v31 offset:57344
    ds_read_b64_tr_b16 v[74:75], v31 offset:57856
    ds_read_b128 v[60:63], v30 offset:4544
    ds_read_b64_tr_b16 v[76:77], v31 offset:61440
    ds_read_b64_tr_b16 v[78:79], v31 offset:61952
    s_add_u32 s53, s53, 1
    s_cmp_gt_u32 s53, 4194304
    s_cbranch_scc1 L_end
    v_xor_b32 v22, s68, v16
    v_xor_b32 v23, s69, v17
    v_bitop3_b32 v22, v22, v18, s70 bitop3:0xf6
    v_bitop3_b32 v23, v23, v19, s71 bitop3:0xf6
    v_bitop3_b32 v22, v22, v23, v2 bitop3:0x54
    v_cmp_ne_u32 vcc, 0, v22
    s_cbranch_vccnz L_gw
L_gok:
    s_waitcnt lgkmcnt(12)
    v_lshl_add_u32 v6, v6, 3, v7
    v_cmp_ne_u32 vcc, 0x44, v6
    s_cbranch_vccnz L_obw
L_mm:
    s_waitcnt lgkmcnt(9)
    v_mfma_f32_16x16x32_bf16 v[44:47], v[64:67], v[48:51], 0
    s_waitcnt lgkmcnt(6)
    v_mfma_f32_16x16x32_bf16 v[44:47], v[68:71], v[52:55], v[44:47]
    s_waitcnt lgkmcnt(3)
    v_mfma_f32_16x16x32_bf16 v[44:47], v[72:75], v[56:59], v[44:47]
    s_waitcnt lgkmcnt(0)
    v_mfma_f32_16x16x32_bf16 v[44:47], v[76:79], v[60:63], v[44:47]
    s_mov_b32 exec_lo, 0x01ff01ff
    s_mov_b32 exec_hi, 0x01ff01ff
    s_nop 5
    v_cndmask_b32 v44, v44, v45, s[60:61]
    v_cndmask_b32 v45, v46, v47, s[60:61]
    v_cndmask_b32 v44, v44, 1.0, s[56:57]
    v_cndmask_b32 v45, v45, 1.0, s[56:57]
    global_atomic_add_f32 v46, v24, v44, s[26:27] sc0 sc1
    global_atomic_add_f32 v47, v24, v45, s[26:27] offset:128 sc0 sc1
    v_and_b32 v16, 0xffff0000, v16
    v_and_b32 v17, 0xffff0000, v17
    v_and_b32 v18, 0xffff0000, v18
    v_and_b32 v19, 0xffff0000, v19
    v_cndmask_b32 v16, v16, v17, s[60:61]
    v_cndmask_b32 v17, v18, v19, s[60:61]
    v_lshlrev_b32 v18, 16, v20
    v_and_b32 v20, 0xffff0000, v20
    v_lshlrev_b32 v19, 16, v21
    v_and_b32 v21, 0xffff0000, v21
    v_cndmask_b32 v18, v18, v20, s[60:61]
    v_cndmask_b32 v19, v19, v21, s[60:61]
    v_and_b32 v7, 1, v10
    v_lshl_add_u32 v26, v7, 1, v26
    s_waitcnt vmcnt(0)
    v_mov_b32_dpp v40, v46 row_newbcast:8 row_mask:0xf bank_mask:0xf
    v_mov_b32_dpp v41, v47 row_newbcast:8 row_mask:0xf bank_mask:0xf
    v_pk_add_f32 v[44:45], v[44:45], v[46:47]
    v_cmp_eq_f32 s[64:65], s62, v40
    v_cmp_eq_f32 s[66:67], s62, v41
    v_cvt_pk_bf16_f32 v44, 0, v44
    v_cvt_pk_bf16_f32 v45, 0, v45
    v_pk_mul_f32 v[44:45], v[44:45], v[16:17]
    v_cvt_pk_bf16_f32 v44, 0, v44
    v_cvt_pk_bf16_f32 v45, 0, v45
    v_pk_add_f32 v[44:45], v[44:45], v[18:19]
    v_cvt_pk_bf16_f32 v44, v44, v45
    s_and_b64 exec, s[64:65], s[58:59]
    s_cbranch_scc0 L_na
    global_store_short v26, v44, s[22:23]
L_na:
    s_and_b64 exec, s[66:67], s[58:59]
    s_cbranch_scc0 L_nb
    global_store_short_d16_hi v26, v44, s[22:23] offset:4
L_nb:
    s_cmp_lg_u32 s74, 0
    s_cbranch_scc1 L_done
    s_and_b64 exec, s[64:65], 1
    s_cbranch_scc0 L_done
    v_mov_b32 v5, 0
    v_mov_b32 v6, s52
    global_store_dword v5, v6, s[26:27]
L_done:
L_end:
    s_endpgm
L_obw:
    s_waitcnt lgkmcnt(0)
    v_cmp_gt_u32 vcc, 0x40, v6
    s_cbranch_vccnz L_obr
L_ob2:
    ds_read_b32 v7, v1 offset:28
    ds_read_b128 v[48:51], v30 offset:4352
    ds_read_b128 v[52:55], v30 offset:4416
    ds_read_b128 v[56:59], v30 offset:4480
    ds_read_b128 v[60:63], v30 offset:4544
    s_add_u32 s53, s53, 1
    s_cmp_gt_u32 s53, 4194304
    s_cbranch_scc1 L_end
    s_waitcnt lgkmcnt(4)
    v_cmp_ne_u32 vcc, 4, v7
    s_cbranch_vccnz L_ob2
    s_waitcnt lgkmcnt(0)
    s_branch L_mm
L_gw:
    global_load_dwordx4 v[16:19], v27, s[26:27] sc1
    s_add_u32 s53, s53, 1
    s_cmp_gt_u32 s53, 4194304
    s_cbranch_scc1 L_end
    s_waitcnt vmcnt(0)
    v_xor_b32 v22, s68, v16
    v_xor_b32 v23, s69, v17
    v_bitop3_b32 v22, v22, v18, s70 bitop3:0xf6
    v_bitop3_b32 v23, v23, v19, s71 bitop3:0xf6
    v_bitop3_b32 v22, v22, v23, v2 bitop3:0x54
    v_cmp_ne_u32 vcc, 0, v22
    s_cbranch_vccnz L_gw
    s_branch L_gok
L_ps3:
    global_store_dwordx4 v27, v[32:35], s[26:27] offset:0 sc1
    s_nop 1
    s_branch L_pd3
L_ps7:
    global_store_dwordx4 v5, v[64:67], s[26:27] offset:0 sc1
    global_store_dwordx4 v5, v[68:71], s[26:27] offset:64 sc1
    global_store_dwordx4 v5, v[72:75], s[26:27] offset:128 sc1
    global_store_dwordx4 v5, v[76:79], s[26:27] offset:192 sc1
    s_nop 1
    s_branch L_pd7
L_ps10:
    global_store_dwordx4 v12, v[20:23], s[26:27] offset:0 sc1
    s_nop 1
    s_branch L_pd10
L_ps14:
    global_store_dwordx4 v20, v[64:67], s[26:27] offset:0 sc1
    global_store_dwordx4 v21, v[68:71], s[26:27] offset:0 sc1
    global_store_dwordx4 v22, v[72:75], s[26:27] offset:0 sc1
    global_store_dwordx4 v23, v[76:79], s[26:27] offset:0 sc1
    global_store_dwordx4 v20, v[80:83], s[26:27] offset:128 sc1
    global_store_dwordx4 v21, v[84:87], s[26:27] offset:128 sc1
    global_store_dwordx4 v22, v[88:91], s[26:27] offset:128 sc1
    global_store_dwordx4 v23, v[92:95], s[26:27] offset:128 sc1
    s_nop 1
    s_branch L_pd14
L_ps19:
    global_store_dwordx4 v5, v[64:67], s[26:27] offset:0 sc1
    global_store_dwordx4 v5, v[68:71], s[26:27] offset:256 sc1
    global_store_dwordx4 v5, v[72:75], s[26:27] offset:512 sc1
    global_store_dwordx4 v5, v[76:79], s[26:27] offset:768 sc1
    s_nop 1
    s_branch L_pd19
L_last:
.section .rodata,"a"
.p2align 6
.amdhsa_kernel recurrent_scan__sliding_block_cached__swiglu_ffn__decode_kernel
  .amdhsa_next_free_vgpr 160
  .amdhsa_next_free_sgpr 102
  .amdhsa_accum_offset 160
  .amdhsa_group_segment_fixed_size 0
  .amdhsa_kernarg_size 96
  .amdhsa_user_sgpr_count 2
  .amdhsa_user_sgpr_kernarg_segment_ptr 1
  .amdhsa_system_sgpr_workgroup_id_x 1
.end_amdhsa_kernel
```
